```python
import torch

def _softmax(x, axis=-1):
    return torch.softmax(x, dim=axis)
def _gelu(x):
    return torch.nn.functional.gelu(x, approximate="tanh")
def _silu(x):
    return torch.nn.functional.silu(x)
def _sigmoid(x):
    return torch.sigmoid(x)
def _layernorm(x, axis=-1, eps=1e-5):
    m = x.mean(dim=axis, keepdim=True)
    v = x.var(dim=axis, keepdim=True, unbiased=False)
    return (x - m) / torch.sqrt(v + eps)
def _scatter_add(tgt, idx, src, axis=0):
    return tgt.clone().index_add_(axis, idx, src)
def _segment_sum(src, seg, n):
    out = torch.zeros((n,) + src.shape[1:], dtype=src.dtype)
    return out.index_add_(0, seg, src)
def _pad(x, pw):
    flat = tuple(v for pair in reversed(pw) for v in pair)
    return torch.nn.functional.pad(x, flat)

kernel_name = 'concat_heads__mha_block_cached__mha_block_cached__near_ridge'

def setup_inputs():

    _w = (lambda a: (lambda t: t.to(torch.bfloat16) if t.is_floating_point() else t)(torch.as_tensor(a)))
    def _A_setup():
        B, Sq, D = 8, 144, 640
        H, Sk, Dh = 32, 512, 192
        return {
            "x": _w((lambda *s: torch.randn(*s, dtype=torch.bfloat16) * 0.8)(B, Sq, D)),
            "k_cache": _w((lambda *s: torch.randn(*s, dtype=torch.bfloat16) * 0.8)(B, H, Sk, Dh)),
            "v_cache": _w((lambda *s: torch.randn(*s, dtype=torch.bfloat16) * 0.05)(B, H, Sk, Dh)),
            "wq": _w((lambda *s: torch.randn(*s, dtype=torch.bfloat16) * 0.8)(D, H * Dh) * (D ** -0.5)),
            "wo": _w((lambda *s: torch.randn(*s, dtype=torch.bfloat16) * 0.05)(H * Dh, D) * ((H * Dh) ** -0.5)),
        }
    _A_in = _A_setup()

    def _B_setup():
        B, Sq, D = 8, 144, 640
        H, Sk, Dh = 32, 512, 192
        return {
            "x": _w((lambda *s: torch.randn(*s, dtype=torch.bfloat16) * 0.8)(B, Sq, D)),
            "k_cache": _w((lambda *s: torch.randn(*s, dtype=torch.bfloat16) * 0.8)(B, H, Sk, Dh)),
            "v_cache": _w((lambda *s: torch.randn(*s, dtype=torch.bfloat16) * 0.05)(B, H, Sk, Dh)),
            "wq": _w((lambda *s: torch.randn(*s, dtype=torch.bfloat16) * 0.8)(D, H * Dh) * (D ** -0.5)),
            "wo": _w((lambda *s: torch.randn(*s, dtype=torch.bfloat16) * 0.05)(H * Dh, D) * ((H * Dh) ** -0.5)),
        }
    _B_in = _B_setup()

    return {
        "A_x": _A_in["x"],
        "A_k_cache": _A_in["k_cache"],
        "A_v_cache": _A_in["v_cache"],
        "A_wq": _A_in["wq"],
        "A_wo": _A_in["wo"],
        "B_x": _B_in["x"],
        "B_k_cache": _B_in["k_cache"],
        "B_v_cache": _B_in["v_cache"],
        "B_wq": _B_in["wq"],
        "B_wo": _B_in["wo"],
    }

def reference(A_x, A_k_cache, A_v_cache, A_wq, A_wo, B_x, B_k_cache, B_v_cache, B_wq, B_wo):
    def _A_ref(x, k_cache, v_cache, wq, wo):
        B, Sq, D = x.shape
        H, Dh = 32, 192
        q = (lambda x, *d: x.permute(*d))((x @ wq).reshape(B, Sq, H, Dh), 0, 2, 1, 3)
        scores = torch.einsum("bhqd,bhkd->bhqk", q, k_cache) * (Dh ** -0.5)
        p = _softmax(scores, axis=-1)
        o = torch.einsum("bhqk,bhkd->bhqd", p, v_cache)
        return (lambda x, *d: x.permute(*d))(o, 0, 2, 1, 3).reshape(B, Sq, H * Dh) @ wo

    def _B_ref(x, k_cache, v_cache, wq, wo):
        B, Sq, D = x.shape
        H, Dh = 32, 192
        q = (lambda x, *d: x.permute(*d))((x @ wq).reshape(B, Sq, H, Dh), 0, 2, 1, 3)
        scores = torch.einsum("bhqd,bhkd->bhqk", q, k_cache) * (Dh ** -0.5)
        p = _softmax(scores, axis=-1)
        o = torch.einsum("bhqk,bhkd->bhqd", p, v_cache)
        return (lambda x, *d: x.permute(*d))(o, 0, 2, 1, 3).reshape(B, Sq, H * Dh) @ wo

    a = _A_ref(A_x, A_k_cache, A_v_cache, A_wq, A_wo)
    b = _B_ref(B_x, B_k_cache, B_v_cache, B_wq, B_wo)
    return torch.concatenate([a, b], axis=-1)
```

```asm
; @launch grid=(256,1,1) block=(512,1,1) lds=163840
.amdgcn_target "amdgcn-amd-amdhsa--gfx950"
.text
.globl concat_heads__mha_block_cached__mha_block_cached__near_ridge_kernel
.p2align 8
.type concat_heads__mha_block_cached__mha_block_cached__near_ridge_kernel,@function
concat_heads__mha_block_cached__mha_block_cached__near_ridge_kernel:
    s_cmp_ge_u32 s2, 256
    s_cbranch_scc1 k1_end
    s_load_dwordx16 s[64:79], s[0:1], 0
    s_load_dwordx8 s[80:87], s[0:1], 64
    s_load_dwordx2 s[88:89], s[0:1], 96
    s_getpc_b64 s[96:97]
K_pc:
    s_and_b32 s97, s97, 0xffff
    s_mov_b32 s98, k1_end-K_pc
    s_mov_b32 s99, 0x20000
    v_lshlrev_b32 v1, 6, v0
    buffer_load_dword v37, v1, s[96:99], 0 offen
    s_mov_b32 s101, 0x51736240
    v_lshrrev_b32 v1, 6, v0
    s_nop 0
    v_readfirstlane_b32 s32, v1
    v_and_b32 v0, 63, v0
    s_and_b32 s33, s32, 3
    s_bfe_u32 s28, s2, 0x10002
    s_bfe_u32 s29, s2, 0x30003
    s_and_b32 s40, s2, 3
    s_lshr_b32 s31, s2, 6
    s_lshl_b32 s40, s40, 2
    s_add_u32 s30, s40, s31
    s_mov_b32 s35, 0x3dd53b95
    s_mul_i32 s44, s33, 3072
    s_mul_i32 s45, s32, 3072
    s_lshl_b32 s46, s32, 10
    s_lshl_b32 s40, s29, 5
    s_add_u32 s40, s40, s30
    s_mul_i32 s34, s40, 196608
    s_lshr_b32 s40, s32, 2
    s_lshl_b32 s40, s40, 4
    s_add_u32 s40, s40, s30
    s_mul_i32 s36, s40, 384
    s_mul_i32 s41, s29, 144
    s_lshl_b32 s42, s32, 4
    s_add_u32 s42, s42, s41
    s_mul_i32 s37, s42, 1280
    s_add_u32 s42, s41, 128
    s_mul_i32 s38, s42, 1280
    s_mov_b32 s59, 0
    s_mov_b32 s62, 0
    s_mul_i32 s43, s31, 2
    s_add_u32 s43, s43, s29
    s_and_b32 s43, s43, 7
    s_mul_i32 s51, s43, 24576
    s_add_u32 s51, s51, s34
    s_cmp_ge_u32 s32, 4
    s_cselect_b32 s48, 3, 2
    s_cselect_b32 s52, 0, 73728
    s_mul_i32 s48, s48, 24576
    s_add_u32 s49, s52, s48
    s_lshl_b32 s40, s33, 13
    s_cmp_eq_u32 s33, 3
    s_cselect_b32 s40, 0, s40
    s_add_u32 s52, s52, s40
    s_add_u32 s34, s34, s40
    s_add_u32 s51, s51, s40
    v_bfe_u32 v48, v0, 2, 2
    v_and_b32 v49, 3, v0
    v_lshrrev_b32 v50, 4, v0
    v_add_u32 v4, 0, v0
    v_lshrrev_b32 v5, 3, v4
    v_mul_u32_u24 v5, 11, v5
    v_lshrrev_b32 v5, 5, v5
    v_mul_u32_u24 v6, 24, v5
    v_sub_u32 v6, v4, v6
    v_mov_b32 v7, s33
    v_lshl_add_u32 v51, v7, 3, v5
    v_lshlrev_b32 v1, 1, v51
    v_and_b32 v1, 28, v1
    v_bfe_u32 v3, s101, v1, 3
    v_xor_b32 v6, v6, v3
    v_mul_u32_u24 v7, 0x3000, v51
    v_lshl_add_u32 v7, v6, 4, v7
    v_add_u32 v12, 0, v7
    v_add_u32 v4, 64, v0
    v_lshrrev_b32 v5, 3, v4
    v_mul_u32_u24 v5, 11, v5
    v_lshrrev_b32 v5, 5, v5
    v_mul_u32_u24 v6, 24, v5
    v_sub_u32 v6, v4, v6
    v_mov_b32 v7, s33
    v_lshl_add_u32 v51, v7, 3, v5
    v_lshlrev_b32 v1, 1, v51
    v_and_b32 v1, 28, v1
    v_bfe_u32 v3, s101, v1, 3
    v_xor_b32 v6, v6, v3
    v_mul_u32_u24 v7, 0x3000, v51
    v_lshl_add_u32 v7, v6, 4, v7
    v_add_u32 v13, 0xfffffc00, v7
    v_add_u32 v4, 0x80, v0
    v_lshrrev_b32 v5, 3, v4
    v_mul_u32_u24 v5, 11, v5
    v_lshrrev_b32 v5, 5, v5
    v_mul_u32_u24 v6, 24, v5
    v_sub_u32 v6, v4, v6
    v_mov_b32 v7, s33
    v_lshl_add_u32 v51, v7, 3, v5
    v_lshlrev_b32 v1, 1, v51
    v_and_b32 v1, 28, v1
    v_bfe_u32 v3, s101, v1, 3
    v_xor_b32 v6, v6, v3
    v_mul_u32_u24 v7, 0x3000, v51
    v_lshl_add_u32 v7, v6, 4, v7
    v_add_u32 v14, 0xfffff800, v7
    v_sub_u32 v4, 0, v50
    v_and_b32 v4, 3, v4
    v_xor_b32 v4, v49, v4
    v_lshrrev_b32 v5, 2, v0
    v_mul_u32_u24 v5, 0x500, v5
    v_lshl_add_u32 v15, v4, 4, v5
    v_cmp_le_u32 vcc, 24, v0
    s_nop 1
    v_cndmask_b32 v1, 0, 1, vcc
    v_mul_u32_u24 v2, 24, v1
    v_sub_u32 v2, v0, v2
    v_mul_u32_u24 v3, 11, v2
    v_lshrrev_b32 v3, 5, v3
    v_mul_u32_u24 v4, 3, v3
    v_sub_u32 v4, v2, v4
    v_mul_u32_u24 v3, 98304, v3
    v_mul_u32_u24 v1, 6144, v1
    v_lshl_add_u32 v3, v4, 7, v3
    v_add_u32 v3, v1, v3
    v_mul_u32_u24 v5, 1280, v0
    v_mov_b32 v4, 0x7fffffff
    v_cmp_gt_u32 vcc, 48, v0
    s_nop 1
    v_cndmask_b32 v36, v4, v3, vcc
    v_cmp_gt_u32 vcc, 36, v0
    s_nop 1
    v_cndmask_b32 v38, v4, v5, vcc
    s_lshl_b32 s40, s33, 6
    s_add_u32 s40, s40, s29
    s_mul_i32 s40, s40, 12288
    s_mul_i32 s39, s30, 384
    s_add_u32 s39, s39, s40
    s_mul_i32 s42, s31, 36
    s_add_u32 s41, s41, s42
    s_mul_i32 s41, s41, 1280
    s_lshl_b32 s42, s33, 7
    s_add_u32 s3, s41, s42
    s_waitcnt lgkmcnt(0)
    s_cmp_eq_u32 s28, 0
    s_cselect_b64 s[64:65], s[64:65], s[74:75]
    s_cselect_b64 s[66:67], s[66:67], s[76:77]
    s_cselect_b64 s[68:69], s[68:69], s[78:79]
    s_cselect_b64 s[70:71], s[70:71], s[80:81]
    s_cselect_b64 s[72:73], s[72:73], s[82:83]
    s_mov_b32 s4, s66
    s_and_b32 s5, s67, 0xffff
    s_mov_b32 s6, 0x3000000
    s_mov_b32 s7, 0x20000
    s_mov_b32 s8, s64
    s_and_b32 s9, s65, 0xffff
    s_mov_b32 s10, 0x168000
    s_mov_b32 s11, 0x20000
    s_mov_b32 s16, s68
    s_and_b32 s17, s69, 0xffff
    s_mov_b32 s18, 0x3000000
    s_mov_b32 s19, 0x20000
    s_mov_b32 s12, s70
    s_and_b32 s13, s71, 0xffff
    s_mov_b32 s14, 0x780000
    s_mov_b32 s15, 0x20000
    s_mov_b32 s24, s88
    s_and_b32 s25, s89, 0xffff
    s_mov_b32 s26, 0x2b40000
    s_mov_b32 s27, 0x20000
    s_mov_b32 s76, s86
    s_and_b32 s77, s87, 0xffff
    s_mov_b32 s78, 0x100
    s_mov_b32 s79, 0x20000
    s_mov_b32 s80, s72
    s_and_b32 s81, s73, 0xffff
    s_mov_b32 s82, 0x780000
    s_mov_b32 s83, 0x20000
    s_cmp_ge_u32 s32, 4
    s_cbranch_scc1 k1_t0y
    s_cmp_ge_u32 s33, 2
    s_cbranch_scc1 KS_t_1001
    buffer_load_dword v37, v36, s[12:15], s39 offen
KS_t_1001:
    s_add_u32 s39, s39, 1572864
    s_add_u32 s3, s3, 256
    s_branch k1_t0
k1_t0y:
    s_cmp_ge_u32 s33, 2
    s_cbranch_scc1 KS_t_1002
    buffer_load_dword v37, v38, s[8:11], s3 offen
KS_t_1002:
    s_add_u32 s39, s39, 1572864
    s_add_u32 s3, s3, 256
k1_t0:
    s_cmp_lg_u32 s32, s59
    s_mov_b32 m0, 131072
    s_cbranch_scc1 KS_skip_1003
    buffer_load_dwordx4 v15, s[8:11], s38 offen lds
KS_skip_1003:
    s_add_u32 m0, s45, 49152
    s_add_u32 s38, s38, 64
    buffer_load_dwordx4 v12, s[12:15], s36 offen lds
    buffer_load_dwordx4 v13, s[12:15], s36 offen offset:1024 lds
    buffer_load_dwordx4 v14, s[12:15], s36 offen offset:2048 lds
    s_add_u32 m0, s46, 122880
    s_add_u32 s36, s36, 393216
    buffer_load_dwordx4 v15, s[8:11], s37 offen lds
    s_add_u32 s37, s37, 64
    s_add_u32 s59, s59, 1
    s_and_b32 s59, s59, 7
    s_cmp_lg_u32 s32, s59
    s_mov_b32 m0, 140288
    s_cbranch_scc1 KS_skip_1004
    buffer_load_dwordx4 v15, s[8:11], s38 offen lds
KS_skip_1004:
    s_add_u32 m0, s45, 73728
    s_add_u32 s38, s38, 64
    buffer_load_dwordx4 v12, s[12:15], s36 offen lds
    buffer_load_dwordx4 v13, s[12:15], s36 offen offset:1024 lds
    buffer_load_dwordx4 v14, s[12:15], s36 offen offset:2048 lds
    s_add_u32 m0, s46, 132096
    s_add_u32 s36, s36, 393216
    buffer_load_dwordx4 v15, s[8:11], s37 offen lds
    s_add_u32 s37, s37, 64
    s_add_u32 s59, s59, 1
    s_and_b32 s59, s59, 7
    s_cmp_lg_u32 s32, 6
    s_cbranch_scc1 k1_noclr
    s_cmp_ge_u32 s2, 8
    s_cbranch_scc1 k1_noclr
    v_and_b32 v1, 31, v0
    v_lshlrev_b32 v1, 10, v1
    v_mov_b32 v4, 0
    v_mov_b32 v5, 0
    v_mov_b32 v6, 0
    v_mov_b32 v7, 0
    s_lshl_b32 s40, s2, 7
    s_add_u32 s40, s40, 28311552
    buffer_store_dwordx4 v[4:7], v1, s[24:27], s40 offen sc1
    v_and_b32 v1, 3, v0
    v_lshlrev_b32 v1, 7, v1
    s_lshl_b32 s40, s2, 9
    s_add_u32 s40, s40, 28344320
    buffer_store_dword v4, v1, s[24:27], s40 offen sc1
k1_noclr:
    v_and_b32 v53, 1, v49
    v_mov_b32 v7, s32
    v_lshrrev_b32 v7, 2, v7
    v_mul_u32_u24 v7, 0x3000, v7
    v_mov_b32 v5, s33
    v_mul_u32_u24 v5, 6, v5
    v_lshrrev_b32 v6, 1, v49
    v_add_u32 v5, v5, v6
    v_add_u32 v52, 0, v5
    v_lshl_or_b32 v51, v50, 3, v48
    v_lshlrev_b32 v1, 1, v51
    v_and_b32 v1, 28, v1
    v_bfe_u32 v3, s101, v1, 3
    v_xor_b32 v3, v52, v3
    v_mul_u32_u24 v1, 0x180, v51
    v_lshl_add_u32 v3, v3, 4, v1
    v_lshl_add_u32 v3, v53, 3, v3
    v_add_u32 v4, 0xc000, v3
    v_add_u32 v16, v7, v4
    v_lshl_or_b32 v51, v50, 3, v48
    v_add_u32 v51, 4, v51
    v_lshlrev_b32 v1, 1, v51
    v_and_b32 v1, 28, v1
    v_bfe_u32 v3, s101, v1, 3
    v_xor_b32 v3, v52, v3
    v_mul_u32_u24 v1, 0x180, v51
    v_lshl_add_u32 v3, v3, 4, v1
    v_lshl_add_u32 v3, v53, 3, v3
    v_add_u32 v4, 0xc000, v3
    v_add_u32 v17, v7, v4
    v_mov_b32 v5, s33
    v_mul_u32_u24 v5, 6, v5
    v_lshrrev_b32 v6, 1, v49
    v_add_u32 v5, v5, v6
    v_add_u32 v52, 2, v5
    v_lshl_or_b32 v51, v50, 3, v48
    v_lshlrev_b32 v1, 1, v51
    v_and_b32 v1, 28, v1
    v_bfe_u32 v3, s101, v1, 3
    v_xor_b32 v3, v52, v3
    v_mul_u32_u24 v1, 0x180, v51
    v_lshl_add_u32 v3, v3, 4, v1
    v_lshl_add_u32 v3, v53, 3, v3
    v_add_u32 v4, 0xc000, v3
    v_add_u32 v18, v7, v4
    v_lshl_or_b32 v51, v50, 3, v48
    v_add_u32 v51, 4, v51
    v_lshlrev_b32 v1, 1, v51
    v_and_b32 v1, 28, v1
    v_bfe_u32 v3, s101, v1, 3
    v_xor_b32 v3, v52, v3
    v_mul_u32_u24 v1, 0x180, v51
    v_lshl_add_u32 v3, v3, 4, v1
    v_lshl_add_u32 v3, v53, 3, v3
    v_add_u32 v4, 0xc000, v3
    v_add_u32 v19, v7, v4
    v_mov_b32 v5, s33
    v_mul_u32_u24 v5, 6, v5
    v_lshrrev_b32 v6, 1, v49
    v_add_u32 v5, v5, v6
    v_add_u32 v52, 4, v5
    v_lshl_or_b32 v51, v50, 3, v48
    v_lshlrev_b32 v1, 1, v51
    v_and_b32 v1, 28, v1
    v_bfe_u32 v3, s101, v1, 3
    v_xor_b32 v3, v52, v3
    v_mul_u32_u24 v1, 0x180, v51
    v_lshl_add_u32 v3, v3, 4, v1
    v_lshl_add_u32 v3, v53, 3, v3
    v_add_u32 v4, 0xc000, v3
    v_add_u32 v20, v7, v4
    v_lshl_or_b32 v51, v50, 3, v48
    v_add_u32 v51, 4, v51
    v_lshlrev_b32 v1, 1, v51
    v_and_b32 v1, 28, v1
    v_bfe_u32 v3, s101, v1, 3
    v_xor_b32 v3, v52, v3
    v_mul_u32_u24 v1, 0x180, v51
    v_lshl_add_u32 v3, v3, 4, v1
    v_lshl_add_u32 v3, v53, 3, v3
    v_add_u32 v4, 0xc000, v3
    v_add_u32 v21, v7, v4
    v_sub_u32 v5, 0, v48
    v_and_b32 v5, 3, v5
    v_xor_b32 v7, v5, v50
    v_and_b32 v6, 15, v0
    v_lshlrev_b32 v6, 6, v6
    v_lshl_add_u32 v7, v7, 4, v6
    v_add_u32 v22, 0x1e000, v7
    v_lshlrev_b32 v23, 4, v0
    v_mov_b32 v56, 0
    v_mov_b32 v57, 0
    v_mov_b32 v58, 0
    v_mov_b32 v59, 0
    v_mov_b32 v60, 0
    v_mov_b32 v61, 0
    v_mov_b32 v62, 0
    v_mov_b32 v63, 0
    v_mov_b32 v64, 0
    v_mov_b32 v65, 0
    v_mov_b32 v66, 0
    v_mov_b32 v67, 0
    v_mov_b32 v68, 0
    v_mov_b32 v69, 0
    v_mov_b32 v70, 0
    v_mov_b32 v71, 0
    v_mov_b32 v72, 0
    v_mov_b32 v73, 0
    v_mov_b32 v74, 0
    v_mov_b32 v75, 0
    v_mov_b32 v76, 0
    v_mov_b32 v77, 0
    v_mov_b32 v78, 0
    v_mov_b32 v79, 0
    v_mov_b32 v80, 0
    v_mov_b32 v81, 0
    v_mov_b32 v82, 0
    v_mov_b32 v83, 0
    v_mov_b32 v84, 0
    v_mov_b32 v85, 0
    v_mov_b32 v86, 0
    v_mov_b32 v87, 0
    v_mov_b32 v88, 0
    v_mov_b32 v89, 0
    v_mov_b32 v90, 0
    v_mov_b32 v91, 0
    v_mov_b32 v92, 0
    v_mov_b32 v93, 0
    v_mov_b32 v94, 0
    v_mov_b32 v95, 0
    v_mov_b32 v96, 0
    v_mov_b32 v97, 0
    v_mov_b32 v98, 0
    v_mov_b32 v99, 0
    v_mov_b32 v100, 0
    v_mov_b32 v101, 0
    v_mov_b32 v102, 0
    v_mov_b32 v103, 0
    v_mov_b32 v104, 0
    v_mov_b32 v105, 0
    v_mov_b32 v106, 0
    v_mov_b32 v107, 0
    v_mov_b32 v108, 0
    v_mov_b32 v109, 0
    v_mov_b32 v110, 0
    v_mov_b32 v111, 0
    v_mov_b32 v112, 0
    v_mov_b32 v113, 0
    v_mov_b32 v114, 0
    v_mov_b32 v115, 0
    v_mov_b32 v116, 0
    v_mov_b32 v117, 0
    v_mov_b32 v118, 0
    v_mov_b32 v119, 0
    v_mov_b32 v120, 0
    v_mov_b32 v121, 0
    v_mov_b32 v122, 0
    v_mov_b32 v123, 0
    v_mov_b32 v124, 0
    v_mov_b32 v125, 0
    v_mov_b32 v126, 0
    v_mov_b32 v127, 0
    v_mov_b32 v128, 0
    v_mov_b32 v129, 0
    v_mov_b32 v130, 0
    v_mov_b32 v131, 0
    v_mov_b32 v132, 0
    v_mov_b32 v133, 0
    v_mov_b32 v134, 0
    v_mov_b32 v135, 0
    v_mov_b32 v136, 0
    v_mov_b32 v137, 0
    v_mov_b32 v138, 0
    v_mov_b32 v139, 0
    v_mov_b32 v140, 0
    v_mov_b32 v141, 0
    v_mov_b32 v142, 0
    v_mov_b32 v143, 0
    v_mov_b32 v144, 0
    v_mov_b32 v145, 0
    v_mov_b32 v146, 0
    v_mov_b32 v147, 0
    v_mov_b32 v148, 0
    v_mov_b32 v149, 0
    v_mov_b32 v150, 0
    v_mov_b32 v151, 0
    v_mov_b32 v152, 0
    v_mov_b32 v153, 0
    v_mov_b32 v154, 0
    v_mov_b32 v155, 0
    v_mov_b32 v156, 0
    v_mov_b32 v157, 0
    v_mov_b32 v158, 0
    v_mov_b32 v159, 0
    v_mov_b32 v160, 0
    v_mov_b32 v161, 0
    v_mov_b32 v162, 0
    v_mov_b32 v163, 0
    s_cmp_ge_u32 s32, 4
    s_cbranch_scc1 k1_qY
    s_mov_b32 s57, 0
    s_mov_b32 s93, 0
    s_lshr_b32 s40, s2, 3
    s_mul_i32 s41, s40, 11
    s_lshr_b32 s41, s41, 5
    s_mul_i32 s41, s41, 3
    s_sub_u32 s22, s41, s40
    s_mul_i32 s22, s22, 1
    s_add_u32 s22, s22, 2
    s_mov_b32 s58, 0
    s_waitcnt vmcnt(4)
    s_barrier
    ds_read_b64_tr_b16 v[208:209], v16 offset:0
    ds_read_b128 v[164:167], v22 offset:0
    ds_read_b64_tr_b16 v[210:211], v17 offset:0
    ds_read_b128 v[168:171], v22 offset:1024
    ds_read_b64_tr_b16 v[212:213], v18 offset:0
    ds_read_b128 v[172:175], v22 offset:2048
    ds_read_b64_tr_b16 v[214:215], v19 offset:0
    ds_read_b128 v[176:179], v22 offset:3072
    ds_read_b64_tr_b16 v[216:217], v20 offset:0
    ds_read_b128 v[180:183], v22 offset:4096
    ds_read_b64_tr_b16 v[218:219], v21 offset:0
    ds_read_b128 v[184:187], v22 offset:5120
    ds_read_b128 v[192:195], v22 offset:7168
    ds_read_b128 v[188:191], v22 offset:6144
    ds_read_b128 v[196:199], v22 offset:8192
    s_cmp_lg_u32 s32, s59
    s_mov_b32 m0, 149504
    s_cbranch_scc1 KS_skip_1005
    buffer_load_dwordx4 v15, s[8:11], s38 offen lds
KS_skip_1005:
    s_add_u32 m0, s45, 98304
    s_add_u32 s38, s38, 64
    buffer_load_dwordx4 v12, s[12:15], s36 offen lds
    buffer_load_dwordx4 v13, s[12:15], s36 offen offset:1024 lds
    buffer_load_dwordx4 v14, s[12:15], s36 offen offset:2048 lds
    s_add_u32 m0, s46, 141312
    s_add_u32 s36, s36, 393216
    buffer_load_dwordx4 v15, s[8:11], s37 offen lds
    s_add_u32 s37, s37, 64
    s_add_u32 s59, s59, 1
    s_and_b32 s59, s59, 7
    s_cmp_ge_u32 s33, 1
    s_cbranch_scc1 KS_t_1006
    buffer_load_dword v37, v36, s[12:15], s39 offen
    buffer_load_dword v37, v38, s[8:11], s3 offen
KS_t_1006:
    s_add_u32 s39, s39, 786432
    s_add_u32 s3, s3, 128
    s_waitcnt lgkmcnt(0)
    s_call_b64 s[60:61], k1_setup2
k1_qpX:
    s_sub_u32 s58, s58, 1
    s_cbranch_scc0 KS_w_1007
    s_mov_b32 s58, 0
    s_waitcnt vmcnt(4)
KS_w_1007:
    s_waitcnt vmcnt(12)
    s_barrier
    v_mfma_f32_16x16x32_bf16 v[56:59], v[208:211], v[164:167], v[56:59]
    ds_read_b64_tr_b16 v[220:221], v16 offset:24576
    v_mfma_f32_16x16x32_bf16 v[92:95], v[212:215], v[164:167], v[92:95]
    v_mfma_f32_16x16x32_bf16 v[128:131], v[216:219], v[164:167], v[128:131]
    ds_read_b128 v[164:167], v22 offset:9216
    v_mfma_f32_16x16x32_bf16 v[60:63], v[208:211], v[168:171], v[60:63]
    ds_read_b64_tr_b16 v[222:223], v17 offset:24576
    v_mfma_f32_16x16x32_bf16 v[96:99], v[212:215], v[168:171], v[96:99]
    v_mfma_f32_16x16x32_bf16 v[132:135], v[216:219], v[168:171], v[132:135]
    ds_read_b128 v[168:171], v22 offset:10240
    v_mfma_f32_16x16x32_bf16 v[64:67], v[208:211], v[172:175], v[64:67]
    ds_read_b64_tr_b16 v[224:225], v18 offset:24576
    v_mfma_f32_16x16x32_bf16 v[100:103], v[212:215], v[172:175], v[100:103]
    v_mfma_f32_16x16x32_bf16 v[136:139], v[216:219], v[172:175], v[136:139]
    ds_read_b128 v[172:175], v22 offset:11264
    v_mfma_f32_16x16x32_bf16 v[68:71], v[208:211], v[176:179], v[68:71]
    ds_read_b64_tr_b16 v[226:227], v19 offset:24576
    v_mfma_f32_16x16x32_bf16 v[104:107], v[212:215], v[176:179], v[104:107]
    v_mfma_f32_16x16x32_bf16 v[140:143], v[216:219], v[176:179], v[140:143]
    ds_read_b128 v[176:179], v22 offset:12288
    v_mfma_f32_16x16x32_bf16 v[72:75], v[208:211], v[180:183], v[72:75]
    ds_read_b64_tr_b16 v[228:229], v20 offset:24576
    v_mfma_f32_16x16x32_bf16 v[108:111], v[212:215], v[180:183], v[108:111]
    v_mfma_f32_16x16x32_bf16 v[144:147], v[216:219], v[180:183], v[144:147]
    ds_read_b128 v[180:183], v22 offset:13312
    v_mfma_f32_16x16x32_bf16 v[76:79], v[208:211], v[184:187], v[76:79]
    ds_read_b64_tr_b16 v[230:231], v21 offset:24576
    v_mfma_f32_16x16x32_bf16 v[112:115], v[212:215], v[184:187], v[112:115]
    v_mfma_f32_16x16x32_bf16 v[148:151], v[216:219], v[184:187], v[148:151]
    ds_read_b128 v[184:187], v22 offset:14336
    v_mfma_f32_16x16x32_bf16 v[80:83], v[208:211], v[188:191], v[80:83]
    ds_read_b128 v[200:203], v22 offset:16384
    v_mfma_f32_16x16x32_bf16 v[116:119], v[212:215], v[188:191], v[116:119]
    v_mfma_f32_16x16x32_bf16 v[152:155], v[216:219], v[188:191], v[152:155]
    ds_read_b128 v[188:191], v22 offset:15360
    v_mfma_f32_16x16x32_bf16 v[84:87], v[208:211], v[192:195], v[84:87]
    ds_read_b128 v[204:207], v22 offset:17408
    v_mfma_f32_16x16x32_bf16 v[120:123], v[212:215], v[192:195], v[120:123]
    v_mfma_f32_16x16x32_bf16 v[156:159], v[216:219], v[192:195], v[156:159]
    v_mfma_f32_16x16x32_bf16 v[88:91], v[208:211], v[196:199], v[88:91]
    v_mfma_f32_16x16x32_bf16 v[124:127], v[212:215], v[196:199], v[124:127]
    v_mfma_f32_16x16x32_bf16 v[160:163], v[216:219], v[196:199], v[160:163]
    s_cmp_lg_u32 s32, s59
    s_mov_b32 m0, 131072
    s_cbranch_scc1 KS_skip_1008
    buffer_load_dwordx4 v15, s[8:11], s38 offen lds
KS_skip_1008:
    s_add_u32 m0, s45, 49152
    s_add_u32 s38, s38, 64
    buffer_load_dwordx4 v12, s[12:15], s36 offen lds
    buffer_load_dwordx4 v13, s[12:15], s36 offen offset:1024 lds
    buffer_load_dwordx4 v14, s[12:15], s36 offen offset:2048 lds
    s_add_u32 m0, s46, 122880
    s_add_u32 s36, s36, 393216
    buffer_load_dwordx4 v15, s[8:11], s37 offen lds
    s_add_u32 s37, s37, 64
    s_add_u32 s59, s59, 1
    s_and_b32 s59, s59, 7
    s_add_u32 s22, s22, 1
    s_bitcmp1_b32 0x4448, s22
    s_cbranch_scc1 KS_s_1013
KS_s_1012:
    s_waitcnt lgkmcnt(0)
    s_sub_u32 s58, s58, 1
    s_cbranch_scc0 KS_w_1016
    s_mov_b32 s58, 0
    s_waitcnt vmcnt(4)
KS_w_1016:
    s_waitcnt vmcnt(12)
    s_barrier
    v_mfma_f32_16x16x32_bf16 v[56:59], v[220:223], v[164:167], v[56:59]
    ds_read_b64_tr_b16 v[208:209], v16 offset:49152
    v_mfma_f32_16x16x32_bf16 v[92:95], v[224:227], v[164:167], v[92:95]
    v_mfma_f32_16x16x32_bf16 v[128:131], v[228:231], v[164:167], v[128:131]
    ds_read_b128 v[164:167], v22 offset:18432
    v_mfma_f32_16x16x32_bf16 v[60:63], v[220:223], v[168:171], v[60:63]
    ds_read_b64_tr_b16 v[210:211], v17 offset:49152
    v_mfma_f32_16x16x32_bf16 v[96:99], v[224:227], v[168:171], v[96:99]
    v_mfma_f32_16x16x32_bf16 v[132:135], v[228:231], v[168:171], v[132:135]
    ds_read_b128 v[168:171], v22 offset:19456
    v_mfma_f32_16x16x32_bf16 v[64:67], v[220:223], v[172:175], v[64:67]
    ds_read_b64_tr_b16 v[212:213], v18 offset:49152
    v_mfma_f32_16x16x32_bf16 v[100:103], v[224:227], v[172:175], v[100:103]
    v_mfma_f32_16x16x32_bf16 v[136:139], v[228:231], v[172:175], v[136:139]
    ds_read_b128 v[172:175], v22 offset:20480
    v_mfma_f32_16x16x32_bf16 v[68:71], v[220:223], v[176:179], v[68:71]
    ds_read_b64_tr_b16 v[214:215], v19 offset:49152
    v_mfma_f32_16x16x32_bf16 v[104:107], v[224:227], v[176:179], v[104:107]
    v_mfma_f32_16x16x32_bf16 v[140:143], v[228:231], v[176:179], v[140:143]
    ds_read_b128 v[176:179], v22 offset:21504
    v_mfma_f32_16x16x32_bf16 v[72:75], v[220:223], v[180:183], v[72:75]
    ds_read_b64_tr_b16 v[216:217], v20 offset:49152
    v_mfma_f32_16x16x32_bf16 v[108:111], v[224:227], v[180:183], v[108:111]
    v_mfma_f32_16x16x32_bf16 v[144:147], v[228:231], v[180:183], v[144:147]
    ds_read_b128 v[180:183], v22 offset:22528
    v_mfma_f32_16x16x32_bf16 v[76:79], v[220:223], v[184:187], v[76:79]
    ds_read_b64_tr_b16 v[218:219], v21 offset:49152
    v_mfma_f32_16x16x32_bf16 v[112:115], v[224:227], v[184:187], v[112:115]
    v_mfma_f32_16x16x32_bf16 v[148:151], v[228:231], v[184:187], v[148:151]
    ds_read_b128 v[184:187], v22 offset:23552
    v_mfma_f32_16x16x32_bf16 v[80:83], v[220:223], v[188:191], v[80:83]
    ds_read_b128 v[192:195], v22 offset:25600
    v_mfma_f32_16x16x32_bf16 v[116:119], v[224:227], v[188:191], v[116:119]
    v_mfma_f32_16x16x32_bf16 v[152:155], v[228:231], v[188:191], v[152:155]
    ds_read_b128 v[188:191], v22 offset:24576
    v_mfma_f32_16x16x32_bf16 v[84:87], v[220:223], v[200:203], v[84:87]
    ds_read_b128 v[196:199], v22 offset:26624
    v_mfma_f32_16x16x32_bf16 v[120:123], v[224:227], v[200:203], v[120:123]
    v_mfma_f32_16x16x32_bf16 v[156:159], v[228:231], v[200:203], v[156:159]
    v_mfma_f32_16x16x32_bf16 v[88:91], v[220:223], v[204:207], v[88:91]
    v_mfma_f32_16x16x32_bf16 v[124:127], v[224:227], v[204:207], v[124:127]
    v_mfma_f32_16x16x32_bf16 v[160:163], v[228:231], v[204:207], v[160:163]
    s_cmp_lg_u32 s32, s59
    s_mov_b32 m0, 140288
    s_cbranch_scc1 KS_skip_1017
    buffer_load_dwordx4 v15, s[8:11], s38 offen lds
KS_skip_1017:
    s_add_u32 m0, s45, 73728
    s_add_u32 s38, s38, 64
    buffer_load_dwordx4 v12, s[12:15], s36 offen lds
    buffer_load_dwordx4 v13, s[12:15], s36 offen offset:1024 lds
    buffer_load_dwordx4 v14, s[12:15], s36 offen offset:2048 lds
    s_add_u32 m0, s46, 132096
    s_add_u32 s36, s36, 393216
    buffer_load_dwordx4 v15, s[8:11], s37 offen lds
    s_add_u32 s37, s37, 64
    s_add_u32 s59, s59, 1
    s_and_b32 s59, s59, 7
    s_add_u32 s22, s22, 1
    s_bitcmp1_b32 0x4448, s22
    s_cbranch_scc1 KS_s_1022
KS_s_1021:
    s_waitcnt lgkmcnt(0)
    s_sub_u32 s58, s58, 1
    s_cbranch_scc0 KS_w_1025
    s_mov_b32 s58, 0
    s_waitcnt vmcnt(4)
KS_w_1025:
    s_waitcnt vmcnt(12)
    s_barrier
    v_mfma_f32_16x16x32_bf16 v[56:59], v[208:211], v[164:167], v[56:59]
    ds_read_b64_tr_b16 v[220:221], v16 offset:0
    v_mfma_f32_16x16x32_bf16 v[92:95], v[212:215], v[164:167], v[92:95]
    v_mfma_f32_16x16x32_bf16 v[128:131], v[216:219], v[164:167], v[128:131]
    ds_read_b128 v[164:167], v22 offset:0
    v_mfma_f32_16x16x32_bf16 v[60:63], v[208:211], v[168:171], v[60:63]
    ds_read_b64_tr_b16 v[222:223], v17 offset:0
    v_mfma_f32_16x16x32_bf16 v[96:99], v[212:215], v[168:171], v[96:99]
    v_mfma_f32_16x16x32_bf16 v[132:135], v[216:219], v[168:171], v[132:135]
    ds_read_b128 v[168:171], v22 offset:1024
    v_mfma_f32_16x16x32_bf16 v[64:67], v[208:211], v[172:175], v[64:67]
    ds_read_b64_tr_b16 v[224:225], v18 offset:0
    v_mfma_f32_16x16x32_bf16 v[100:103], v[212:215], v[172:175], v[100:103]
    v_mfma_f32_16x16x32_bf16 v[136:139], v[216:219], v[172:175], v[136:139]
    ds_read_b128 v[172:175], v22 offset:2048
    v_mfma_f32_16x16x32_bf16 v[68:71], v[208:211], v[176:179], v[68:71]
    ds_read_b64_tr_b16 v[226:227], v19 offset:0
    v_mfma_f32_16x16x32_bf16 v[104:107], v[212:215], v[176:179], v[104:107]
    v_mfma_f32_16x16x32_bf16 v[140:143], v[216:219], v[176:179], v[140:143]
    ds_read_b128 v[176:179], v22 offset:3072
    v_mfma_f32_16x16x32_bf16 v[72:75], v[208:211], v[180:183], v[72:75]
    ds_read_b64_tr_b16 v[228:229], v20 offset:0
    v_mfma_f32_16x16x32_bf16 v[108:111], v[212:215], v[180:183], v[108:111]
    v_mfma_f32_16x16x32_bf16 v[144:147], v[216:219], v[180:183], v[144:147]
    ds_read_b128 v[180:183], v22 offset:4096
    v_mfma_f32_16x16x32_bf16 v[76:79], v[208:211], v[184:187], v[76:79]
    ds_read_b64_tr_b16 v[230:231], v21 offset:0
    v_mfma_f32_16x16x32_bf16 v[112:115], v[212:215], v[184:187], v[112:115]
    v_mfma_f32_16x16x32_bf16 v[148:151], v[216:219], v[184:187], v[148:151]
    ds_read_b128 v[184:187], v22 offset:5120
    v_mfma_f32_16x16x32_bf16 v[80:83], v[208:211], v[188:191], v[80:83]
    ds_read_b128 v[200:203], v22 offset:7168
    v_mfma_f32_16x16x32_bf16 v[116:119], v[212:215], v[188:191], v[116:119]
    v_mfma_f32_16x16x32_bf16 v[152:155], v[216:219], v[188:191], v[152:155]
    ds_read_b128 v[188:191], v22 offset:6144
    v_mfma_f32_16x16x32_bf16 v[84:87], v[208:211], v[192:195], v[84:87]
    ds_read_b128 v[204:207], v22 offset:8192
    v_mfma_f32_16x16x32_bf16 v[120:123], v[212:215], v[192:195], v[120:123]
    v_mfma_f32_16x16x32_bf16 v[156:159], v[216:219], v[192:195], v[156:159]
    v_mfma_f32_16x16x32_bf16 v[88:91], v[208:211], v[196:199], v[88:91]
    v_mfma_f32_16x16x32_bf16 v[124:127], v[212:215], v[196:199], v[124:127]
    v_mfma_f32_16x16x32_bf16 v[160:163], v[216:219], v[196:199], v[160:163]
    s_cmp_lg_u32 s32, s59
    s_mov_b32 m0, 149504
    s_cbranch_scc1 KS_skip_1026
    buffer_load_dwordx4 v15, s[8:11], s38 offen lds
KS_skip_1026:
    s_add_u32 m0, s45, 98304
    s_add_u32 s38, s38, 64
    buffer_load_dwordx4 v12, s[12:15], s36 offen lds
    buffer_load_dwordx4 v13, s[12:15], s36 offen offset:1024 lds
    buffer_load_dwordx4 v14, s[12:15], s36 offen offset:2048 lds
    s_add_u32 m0, s46, 141312
    s_add_u32 s36, s36, 393216
    buffer_load_dwordx4 v15, s[8:11], s37 offen lds
    s_add_u32 s37, s37, 64
    s_add_u32 s59, s59, 1
    s_and_b32 s59, s59, 7
    s_add_u32 s22, s22, 1
    s_bitcmp1_b32 0x4448, s22
    s_cbranch_scc1 KS_s_1031
KS_s_1030:
    s_waitcnt lgkmcnt(0)
    s_sub_u32 s58, s58, 1
    s_cbranch_scc0 KS_w_1034
    s_mov_b32 s58, 0
    s_waitcnt vmcnt(4)
KS_w_1034:
    s_waitcnt vmcnt(12)
    s_barrier
    v_mfma_f32_16x16x32_bf16 v[56:59], v[220:223], v[164:167], v[56:59]
    ds_read_b64_tr_b16 v[208:209], v16 offset:24576
    v_mfma_f32_16x16x32_bf16 v[92:95], v[224:227], v[164:167], v[92:95]
    v_mfma_f32_16x16x32_bf16 v[128:131], v[228:231], v[164:167], v[128:131]
    ds_read_b128 v[164:167], v22 offset:9216
    v_mfma_f32_16x16x32_bf16 v[60:63], v[220:223], v[168:171], v[60:63]
    ds_read_b64_tr_b16 v[210:211], v17 offset:24576
    v_mfma_f32_16x16x32_bf16 v[96:99], v[224:227], v[168:171], v[96:99]
    v_mfma_f32_16x16x32_bf16 v[132:135], v[228:231], v[168:171], v[132:135]
    ds_read_b128 v[168:171], v22 offset:10240
    v_mfma_f32_16x16x32_bf16 v[64:67], v[220:223], v[172:175], v[64:67]
    ds_read_b64_tr_b16 v[212:213], v18 offset:24576
    v_mfma_f32_16x16x32_bf16 v[100:103], v[224:227], v[172:175], v[100:103]
    v_mfma_f32_16x16x32_bf16 v[136:139], v[228:231], v[172:175], v[136:139]
    ds_read_b128 v[172:175], v22 offset:11264
    v_mfma_f32_16x16x32_bf16 v[68:71], v[220:223], v[176:179], v[68:71]
    ds_read_b64_tr_b16 v[214:215], v19 offset:24576
    v_mfma_f32_16x16x32_bf16 v[104:107], v[224:227], v[176:179], v[104:107]
    v_mfma_f32_16x16x32_bf16 v[140:143], v[228:231], v[176:179], v[140:143]
    ds_read_b128 v[176:179], v22 offset:12288
    v_mfma_f32_16x16x32_bf16 v[72:75], v[220:223], v[180:183], v[72:75]
    ds_read_b64_tr_b16 v[216:217], v20 offset:24576
    v_mfma_f32_16x16x32_bf16 v[108:111], v[224:227], v[180:183], v[108:111]
    v_mfma_f32_16x16x32_bf16 v[144:147], v[228:231], v[180:183], v[144:147]
    ds_read_b128 v[180:183], v22 offset:13312
    v_mfma_f32_16x16x32_bf16 v[76:79], v[220:223], v[184:187], v[76:79]
    ds_read_b64_tr_b16 v[218:219], v21 offset:24576
    v_mfma_f32_16x16x32_bf16 v[112:115], v[224:227], v[184:187], v[112:115]
    v_mfma_f32_16x16x32_bf16 v[148:151], v[228:231], v[184:187], v[148:151]
    ds_read_b128 v[184:187], v22 offset:14336
    v_mfma_f32_16x16x32_bf16 v[80:83], v[220:223], v[188:191], v[80:83]
    ds_read_b128 v[192:195], v22 offset:16384
    v_mfma_f32_16x16x32_bf16 v[116:119], v[224:227], v[188:191], v[116:119]
    v_mfma_f32_16x16x32_bf16 v[152:155], v[228:231], v[188:191], v[152:155]
    ds_read_b128 v[188:191], v22 offset:15360
    v_mfma_f32_16x16x32_bf16 v[84:87], v[220:223], v[200:203], v[84:87]
    ds_read_b128 v[196:199], v22 offset:17408
    v_mfma_f32_16x16x32_bf16 v[120:123], v[224:227], v[200:203], v[120:123]
    v_mfma_f32_16x16x32_bf16 v[156:159], v[228:231], v[200:203], v[156:159]
    v_mfma_f32_16x16x32_bf16 v[88:91], v[220:223], v[204:207], v[88:91]
    v_mfma_f32_16x16x32_bf16 v[124:127], v[224:227], v[204:207], v[124:127]
    v_mfma_f32_16x16x32_bf16 v[160:163], v[228:231], v[204:207], v[160:163]
    s_cmp_lg_u32 s32, s59
    s_mov_b32 m0, 131072
    s_cbranch_scc1 KS_skip_1035
    buffer_load_dwordx4 v15, s[8:11], s38 offen lds
KS_skip_1035:
    s_add_u32 m0, s45, 49152
    s_add_u32 s38, s38, 64
    buffer_load_dwordx4 v12, s[12:15], s36 offen lds
    buffer_load_dwordx4 v13, s[12:15], s36 offen offset:1024 lds
    buffer_load_dwordx4 v14, s[12:15], s36 offen offset:2048 lds
    s_add_u32 m0, s46, 122880
    s_add_u32 s36, s36, 393216
    buffer_load_dwordx4 v15, s[8:11], s37 offen lds
    s_add_u32 s37, s37, 64
    s_add_u32 s59, s59, 1
    s_and_b32 s59, s59, 7
    s_add_u32 s22, s22, 1
    s_bitcmp1_b32 0x4448, s22
    s_cbranch_scc1 KS_s_1040
KS_s_1039:
    s_waitcnt lgkmcnt(0)
    s_sub_u32 s58, s58, 1
    s_cbranch_scc0 KS_w_1043
    s_mov_b32 s58, 0
    s_waitcnt vmcnt(4)
KS_w_1043:
    s_waitcnt vmcnt(12)
    s_barrier
    v_mfma_f32_16x16x32_bf16 v[56:59], v[208:211], v[164:167], v[56:59]
    ds_read_b64_tr_b16 v[220:221], v16 offset:49152
    v_mfma_f32_16x16x32_bf16 v[92:95], v[212:215], v[164:167], v[92:95]
    v_mfma_f32_16x16x32_bf16 v[128:131], v[216:219], v[164:167], v[128:131]
    ds_read_b128 v[164:167], v22 offset:18432
    v_mfma_f32_16x16x32_bf16 v[60:63], v[208:211], v[168:171], v[60:63]
    ds_read_b64_tr_b16 v[222:223], v17 offset:49152
    v_mfma_f32_16x16x32_bf16 v[96:99], v[212:215], v[168:171], v[96:99]
    v_mfma_f32_16x16x32_bf16 v[132:135], v[216:219], v[168:171], v[132:135]
    ds_read_b128 v[168:171], v22 offset:19456
    v_mfma_f32_16x16x32_bf16 v[64:67], v[208:211], v[172:175], v[64:67]
    ds_read_b64_tr_b16 v[224:225], v18 offset:49152
    v_mfma_f32_16x16x32_bf16 v[100:103], v[212:215], v[172:175], v[100:103]
    v_mfma_f32_16x16x32_bf16 v[136:139], v[216:219], v[172:175], v[136:139]
    ds_read_b128 v[172:175], v22 offset:20480
    v_mfma_f32_16x16x32_bf16 v[68:71], v[208:211], v[176:179], v[68:71]
    ds_read_b64_tr_b16 v[226:227], v19 offset:49152
    v_mfma_f32_16x16x32_bf16 v[104:107], v[212:215], v[176:179], v[104:107]
    v_mfma_f32_16x16x32_bf16 v[140:143], v[216:219], v[176:179], v[140:143]
    ds_read_b128 v[176:179], v22 offset:21504
    v_mfma_f32_16x16x32_bf16 v[72:75], v[208:211], v[180:183], v[72:75]
    ds_read_b64_tr_b16 v[228:229], v20 offset:49152
    v_mfma_f32_16x16x32_bf16 v[108:111], v[212:215], v[180:183], v[108:111]
    v_mfma_f32_16x16x32_bf16 v[144:147], v[216:219], v[180:183], v[144:147]
    ds_read_b128 v[180:183], v22 offset:22528
    v_mfma_f32_16x16x32_bf16 v[76:79], v[208:211], v[184:187], v[76:79]
    ds_read_b64_tr_b16 v[230:231], v21 offset:49152
    v_mfma_f32_16x16x32_bf16 v[112:115], v[212:215], v[184:187], v[112:115]
    v_mfma_f32_16x16x32_bf16 v[148:151], v[216:219], v[184:187], v[148:151]
    ds_read_b128 v[184:187], v22 offset:23552
    v_mfma_f32_16x16x32_bf16 v[80:83], v[208:211], v[188:191], v[80:83]
    ds_read_b128 v[200:203], v22 offset:25600
    v_mfma_f32_16x16x32_bf16 v[116:119], v[212:215], v[188:191], v[116:119]
    v_mfma_f32_16x16x32_bf16 v[152:155], v[216:219], v[188:191], v[152:155]
    ds_read_b128 v[188:191], v22 offset:24576
    v_mfma_f32_16x16x32_bf16 v[84:87], v[208:211], v[192:195], v[84:87]
    ds_read_b128 v[204:207], v22 offset:26624
    v_mfma_f32_16x16x32_bf16 v[120:123], v[212:215], v[192:195], v[120:123]
    v_mfma_f32_16x16x32_bf16 v[156:159], v[216:219], v[192:195], v[156:159]
    v_mfma_f32_16x16x32_bf16 v[88:91], v[208:211], v[196:199], v[88:91]
    v_mfma_f32_16x16x32_bf16 v[124:127], v[212:215], v[196:199], v[124:127]
    v_mfma_f32_16x16x32_bf16 v[160:163], v[216:219], v[196:199], v[160:163]
    s_cmp_lg_u32 s32, s59
    s_mov_b32 m0, 140288
    s_cbranch_scc1 KS_skip_1044
    buffer_load_dwordx4 v15, s[8:11], s38 offen lds
KS_skip_1044:
    s_add_u32 m0, s45, 73728
    s_add_u32 s38, s38, 64
    buffer_load_dwordx4 v12, s[12:15], s36 offen lds
    buffer_load_dwordx4 v13, s[12:15], s36 offen offset:1024 lds
    buffer_load_dwordx4 v14, s[12:15], s36 offen offset:2048 lds
    s_add_u32 m0, s46, 132096
    s_add_u32 s36, s36, 393216
    buffer_load_dwordx4 v15, s[8:11], s37 offen lds
    s_add_u32 s37, s37, 64
    s_add_u32 s59, s59, 1
    s_and_b32 s59, s59, 7
    s_add_u32 s22, s22, 1
    s_bitcmp1_b32 0x4448, s22
    s_cbranch_scc1 KS_s_1049
KS_s_1048:
    s_waitcnt lgkmcnt(0)
    s_sub_u32 s58, s58, 1
    s_cbranch_scc0 KS_w_1052
    s_mov_b32 s58, 0
    s_waitcnt vmcnt(4)
KS_w_1052:
    s_waitcnt vmcnt(12)
    s_barrier
    v_mfma_f32_16x16x32_bf16 v[56:59], v[220:223], v[164:167], v[56:59]
    ds_read_b64_tr_b16 v[208:209], v16 offset:0
    v_mfma_f32_16x16x32_bf16 v[92:95], v[224:227], v[164:167], v[92:95]
    v_mfma_f32_16x16x32_bf16 v[128:131], v[228:231], v[164:167], v[128:131]
    ds_read_b128 v[164:167], v22 offset:0
    v_mfma_f32_16x16x32_bf16 v[60:63], v[220:223], v[168:171], v[60:63]
    ds_read_b64_tr_b16 v[210:211], v17 offset:0
    v_mfma_f32_16x16x32_bf16 v[96:99], v[224:227], v[168:171], v[96:99]
    v_mfma_f32_16x16x32_bf16 v[132:135], v[228:231], v[168:171], v[132:135]
    ds_read_b128 v[168:171], v22 offset:1024
    v_mfma_f32_16x16x32_bf16 v[64:67], v[220:223], v[172:175], v[64:67]
    ds_read_b64_tr_b16 v[212:213], v18 offset:0
    v_mfma_f32_16x16x32_bf16 v[100:103], v[224:227], v[172:175], v[100:103]
    v_mfma_f32_16x16x32_bf16 v[136:139], v[228:231], v[172:175], v[136:139]
    ds_read_b128 v[172:175], v22 offset:2048
    v_mfma_f32_16x16x32_bf16 v[68:71], v[220:223], v[176:179], v[68:71]
    ds_read_b64_tr_b16 v[214:215], v19 offset:0
    v_mfma_f32_16x16x32_bf16 v[104:107], v[224:227], v[176:179], v[104:107]
    v_mfma_f32_16x16x32_bf16 v[140:143], v[228:231], v[176:179], v[140:143]
    ds_read_b128 v[176:179], v22 offset:3072
    v_mfma_f32_16x16x32_bf16 v[72:75], v[220:223], v[180:183], v[72:75]
    ds_read_b64_tr_b16 v[216:217], v20 offset:0
    v_mfma_f32_16x16x32_bf16 v[108:111], v[224:227], v[180:183], v[108:111]
    v_mfma_f32_16x16x32_bf16 v[144:147], v[228:231], v[180:183], v[144:147]
    ds_read_b128 v[180:183], v22 offset:4096
    v_mfma_f32_16x16x32_bf16 v[76:79], v[220:223], v[184:187], v[76:79]
    ds_read_b64_tr_b16 v[218:219], v21 offset:0
    v_mfma_f32_16x16x32_bf16 v[112:115], v[224:227], v[184:187], v[112:115]
    v_mfma_f32_16x16x32_bf16 v[148:151], v[228:231], v[184:187], v[148:151]
    ds_read_b128 v[184:187], v22 offset:5120
    v_mfma_f32_16x16x32_bf16 v[80:83], v[220:223], v[188:191], v[80:83]
    ds_read_b128 v[192:195], v22 offset:7168
    v_mfma_f32_16x16x32_bf16 v[116:119], v[224:227], v[188:191], v[116:119]
    v_mfma_f32_16x16x32_bf16 v[152:155], v[228:231], v[188:191], v[152:155]
    ds_read_b128 v[188:191], v22 offset:6144
    v_mfma_f32_16x16x32_bf16 v[84:87], v[220:223], v[200:203], v[84:87]
    ds_read_b128 v[196:199], v22 offset:8192
    v_mfma_f32_16x16x32_bf16 v[120:123], v[224:227], v[200:203], v[120:123]
    v_mfma_f32_16x16x32_bf16 v[156:159], v[228:231], v[200:203], v[156:159]
    v_mfma_f32_16x16x32_bf16 v[88:91], v[220:223], v[204:207], v[88:91]
    v_mfma_f32_16x16x32_bf16 v[124:127], v[224:227], v[204:207], v[124:127]
    v_mfma_f32_16x16x32_bf16 v[160:163], v[228:231], v[204:207], v[160:163]
    s_cmp_eq_u32 s57, 2
    s_cbranch_scc1 KS_wo_1054
    s_cmp_lg_u32 s32, s59
    s_mov_b32 m0, 149504
    s_cbranch_scc1 KS_skip_1053
    buffer_load_dwordx4 v15, s[8:11], s38 offen lds
KS_skip_1053:
    s_add_u32 m0, s45, 98304
    s_add_u32 s38, s38, 64
    buffer_load_dwordx4 v12, s[12:15], s36 offen lds
    buffer_load_dwordx4 v13, s[12:15], s36 offen offset:1024 lds
    buffer_load_dwordx4 v14, s[12:15], s36 offen offset:2048 lds
    s_add_u32 m0, s46, 141312
    s_add_u32 s36, s36, 393216
    buffer_load_dwordx4 v15, s[8:11], s37 offen lds
    s_add_u32 s37, s37, 64
    s_add_u32 s59, s59, 1
    s_and_b32 s59, s59, 7
KS_wo_1055:
    s_add_u32 s22, s22, 1
    s_bitcmp1_b32 0x4448, s22
    s_cbranch_scc1 KS_s_1060
KS_s_1059:
    s_waitcnt lgkmcnt(0)
    s_add_u32 s57, s57, 1
    s_cmp_lt_u32 s57, 3
    s_cbranch_scc1 k1_qpX
    s_waitcnt vmcnt(2)
    s_barrier
    v_mfma_f32_16x16x32_bf16 v[56:59], v[208:211], v[164:167], v[56:59]
    ds_read_b64_tr_b16 v[220:221], v16 offset:24576
    v_mfma_f32_16x16x32_bf16 v[92:95], v[212:215], v[164:167], v[92:95]
    v_mfma_f32_16x16x32_bf16 v[128:131], v[216:219], v[164:167], v[128:131]
    ds_read_b128 v[164:167], v22 offset:9216
    v_mfma_f32_16x16x32_bf16 v[60:63], v[208:211], v[168:171], v[60:63]
    ds_read_b64_tr_b16 v[222:223], v17 offset:24576
    v_mfma_f32_16x16x32_bf16 v[96:99], v[212:215], v[168:171], v[96:99]
    v_mfma_f32_16x16x32_bf16 v[132:135], v[216:219], v[168:171], v[132:135]
    ds_read_b128 v[168:171], v22 offset:10240
    v_mfma_f32_16x16x32_bf16 v[64:67], v[208:211], v[172:175], v[64:67]
    ds_read_b64_tr_b16 v[224:225], v18 offset:24576
    v_mfma_f32_16x16x32_bf16 v[100:103], v[212:215], v[172:175], v[100:103]
    v_mfma_f32_16x16x32_bf16 v[136:139], v[216:219], v[172:175], v[136:139]
    ds_read_b128 v[172:175], v22 offset:11264
    v_mfma_f32_16x16x32_bf16 v[68:71], v[208:211], v[176:179], v[68:71]
    ds_read_b64_tr_b16 v[226:227], v19 offset:24576
    v_mfma_f32_16x16x32_bf16 v[104:107], v[212:215], v[176:179], v[104:107]
    v_mfma_f32_16x16x32_bf16 v[140:143], v[216:219], v[176:179], v[140:143]
    ds_read_b128 v[176:179], v22 offset:12288
    v_mfma_f32_16x16x32_bf16 v[72:75], v[208:211], v[180:183], v[72:75]
    ds_read_b64_tr_b16 v[228:229], v20 offset:24576
    v_mfma_f32_16x16x32_bf16 v[108:111], v[212:215], v[180:183], v[108:111]
    v_mfma_f32_16x16x32_bf16 v[144:147], v[216:219], v[180:183], v[144:147]
    ds_read_b128 v[180:183], v22 offset:13312
    v_mfma_f32_16x16x32_bf16 v[76:79], v[208:211], v[184:187], v[76:79]
    ds_read_b64_tr_b16 v[230:231], v21 offset:24576
    v_mfma_f32_16x16x32_bf16 v[112:115], v[212:215], v[184:187], v[112:115]
    v_mfma_f32_16x16x32_bf16 v[148:151], v[216:219], v[184:187], v[148:151]
    ds_read_b128 v[184:187], v22 offset:14336
    v_mfma_f32_16x16x32_bf16 v[80:83], v[208:211], v[188:191], v[80:83]
    ds_read_b128 v[200:203], v22 offset:16384
    v_mfma_f32_16x16x32_bf16 v[116:119], v[212:215], v[188:191], v[116:119]
    v_mfma_f32_16x16x32_bf16 v[152:155], v[216:219], v[188:191], v[152:155]
    ds_read_b128 v[188:191], v22 offset:15360
    v_mfma_f32_16x16x32_bf16 v[84:87], v[208:211], v[192:195], v[84:87]
    ds_read_b128 v[204:207], v22 offset:17408
    v_mfma_f32_16x16x32_bf16 v[120:123], v[212:215], v[192:195], v[120:123]
    v_mfma_f32_16x16x32_bf16 v[156:159], v[216:219], v[192:195], v[156:159]
    v_mfma_f32_16x16x32_bf16 v[88:91], v[208:211], v[196:199], v[88:91]
    v_mfma_f32_16x16x32_bf16 v[124:127], v[212:215], v[196:199], v[124:127]
    v_mfma_f32_16x16x32_bf16 v[160:163], v[216:219], v[196:199], v[160:163]
    s_waitcnt lgkmcnt(0)
    s_setprio 0
    s_branch k1_qdone
k1_qY:
    s_mov_b32 s57, 0
    s_mov_b32 s93, 0
    s_lshr_b32 s40, s2, 3
    s_mul_i32 s41, s40, 11
    s_lshr_b32 s41, s41, 5
    s_mul_i32 s41, s41, 3
    s_sub_u32 s22, s41, s40
    s_mul_i32 s22, s22, 1
    s_add_u32 s22, s22, 2
    s_mov_b32 s58, 0
    s_waitcnt vmcnt(4)
    s_barrier
    s_cmp_lg_u32 s32, s59
    s_mov_b32 m0, 149504
    s_cbranch_scc1 KS_skip_1063
    buffer_load_dwordx4 v15, s[8:11], s38 offen lds
KS_skip_1063:
    s_add_u32 m0, s45, 98304
    s_add_u32 s38, s38, 64
    buffer_load_dwordx4 v12, s[12:15], s36 offen lds
    buffer_load_dwordx4 v13, s[12:15], s36 offen offset:1024 lds
    buffer_load_dwordx4 v14, s[12:15], s36 offen offset:2048 lds
    s_add_u32 m0, s46, 141312
    s_add_u32 s36, s36, 393216
    buffer_load_dwordx4 v15, s[8:11], s37 offen lds
    s_add_u32 s37, s37, 64
    s_add_u32 s59, s59, 1
    s_and_b32 s59, s59, 7
    ds_read_b64_tr_b16 v[208:209], v16 offset:0
    ds_read_b128 v[164:167], v22 offset:0
    ds_read_b64_tr_b16 v[210:211], v17 offset:0
    ds_read_b128 v[168:171], v22 offset:1024
    ds_read_b64_tr_b16 v[212:213], v18 offset:0
    ds_read_b128 v[172:175], v22 offset:2048
    ds_read_b64_tr_b16 v[214:215], v19 offset:0
    ds_read_b128 v[176:179], v22 offset:3072
    ds_read_b64_tr_b16 v[216:217], v20 offset:0
    ds_read_b128 v[180:183], v22 offset:4096
    ds_read_b64_tr_b16 v[218:219], v21 offset:0
    ds_read_b128 v[184:187], v22 offset:5120
    ds_read_b128 v[192:195], v22 offset:7168
    ds_read_b128 v[188:191], v22 offset:6144
    ds_read_b128 v[196:199], v22 offset:8192
    s_waitcnt lgkmcnt(0)
    s_call_b64 s[60:61], k1_setup2
k1_qpY:
    s_waitcnt vmcnt(4)
    s_barrier
    s_cmp_lg_u32 s32, s59
    s_mov_b32 m0, 131072
    s_cbranch_scc1 KS_skip_1064
    buffer_load_dwordx4 v15, s[8:11], s38 offen lds
KS_skip_1064:
    s_add_u32 m0, s45, 49152
    s_add_u32 s38, s38, 64
    buffer_load_dwordx4 v12, s[12:15], s36 offen lds
    buffer_load_dwordx4 v13, s[12:15], s36 offen offset:1024 lds
    buffer_load_dwordx4 v14, s[12:15], s36 offen offset:2048 lds
    s_add_u32 m0, s46, 122880
    s_add_u32 s36, s36, 393216
    buffer_load_dwordx4 v15, s[8:11], s37 offen lds
    s_add_u32 s37, s37, 64
    s_add_u32 s59, s59, 1
    s_and_b32 s59, s59, 7
    v_mfma_f32_16x16x32_bf16 v[56:59], v[208:211], v[164:167], v[56:59]
    ds_read_b64_tr_b16 v[220:221], v16 offset:24576
    v_mfma_f32_16x16x32_bf16 v[92:95], v[212:215], v[164:167], v[92:95]
    v_mfma_f32_16x16x32_bf16 v[128:131], v[216:219], v[164:167], v[128:131]
    ds_read_b128 v[164:167], v22 offset:9216
    v_mfma_f32_16x16x32_bf16 v[60:63], v[208:211], v[168:171], v[60:63]
    ds_read_b64_tr_b16 v[222:223], v17 offset:24576
    v_mfma_f32_16x16x32_bf16 v[96:99], v[212:215], v[168:171], v[96:99]
    v_mfma_f32_16x16x32_bf16 v[132:135], v[216:219], v[168:171], v[132:135]
    ds_read_b128 v[168:171], v22 offset:10240
    v_mfma_f32_16x16x32_bf16 v[64:67], v[208:211], v[172:175], v[64:67]
    ds_read_b64_tr_b16 v[224:225], v18 offset:24576
    v_mfma_f32_16x16x32_bf16 v[100:103], v[212:215], v[172:175], v[100:103]
    v_mfma_f32_16x16x32_bf16 v[136:139], v[216:219], v[172:175], v[136:139]
    ds_read_b128 v[172:175], v22 offset:11264
    v_mfma_f32_16x16x32_bf16 v[68:71], v[208:211], v[176:179], v[68:71]
    ds_read_b64_tr_b16 v[226:227], v19 offset:24576
    v_mfma_f32_16x16x32_bf16 v[104:107], v[212:215], v[176:179], v[104:107]
    v_mfma_f32_16x16x32_bf16 v[140:143], v[216:219], v[176:179], v[140:143]
    ds_read_b128 v[176:179], v22 offset:12288
    v_mfma_f32_16x16x32_bf16 v[72:75], v[208:211], v[180:183], v[72:75]
    ds_read_b64_tr_b16 v[228:229], v20 offset:24576
    v_mfma_f32_16x16x32_bf16 v[108:111], v[212:215], v[180:183], v[108:111]
    v_mfma_f32_16x16x32_bf16 v[144:147], v[216:219], v[180:183], v[144:147]
    ds_read_b128 v[180:183], v22 offset:13312
    v_mfma_f32_16x16x32_bf16 v[76:79], v[208:211], v[184:187], v[76:79]
    ds_read_b64_tr_b16 v[230:231], v21 offset:24576
    v_mfma_f32_16x16x32_bf16 v[112:115], v[212:215], v[184:187], v[112:115]
    v_mfma_f32_16x16x32_bf16 v[148:151], v[216:219], v[184:187], v[148:151]
    ds_read_b128 v[184:187], v22 offset:14336
    v_mfma_f32_16x16x32_bf16 v[80:83], v[208:211], v[188:191], v[80:83]
    ds_read_b128 v[200:203], v22 offset:16384
    v_mfma_f32_16x16x32_bf16 v[116:119], v[212:215], v[188:191], v[116:119]
    v_mfma_f32_16x16x32_bf16 v[152:155], v[216:219], v[188:191], v[152:155]
    ds_read_b128 v[188:191], v22 offset:15360
    v_mfma_f32_16x16x32_bf16 v[84:87], v[208:211], v[192:195], v[84:87]
    ds_read_b128 v[204:207], v22 offset:17408
    v_mfma_f32_16x16x32_bf16 v[120:123], v[212:215], v[192:195], v[120:123]
    v_mfma_f32_16x16x32_bf16 v[156:159], v[216:219], v[192:195], v[156:159]
    v_mfma_f32_16x16x32_bf16 v[88:91], v[208:211], v[196:199], v[88:91]
    v_mfma_f32_16x16x32_bf16 v[124:127], v[212:215], v[196:199], v[124:127]
    v_mfma_f32_16x16x32_bf16 v[160:163], v[216:219], v[196:199], v[160:163]
    s_waitcnt lgkmcnt(0)
    s_waitcnt vmcnt(4)
    s_barrier
    s_cmp_lg_u32 s32, s59
    s_mov_b32 m0, 140288
    s_cbranch_scc1 KS_skip_1065
    buffer_load_dwordx4 v15, s[8:11], s38 offen lds
KS_skip_1065:
    s_add_u32 m0, s45, 73728
    s_add_u32 s38, s38, 64
    buffer_load_dwordx4 v12, s[12:15], s36 offen lds
    buffer_load_dwordx4 v13, s[12:15], s36 offen offset:1024 lds
    buffer_load_dwordx4 v14, s[12:15], s36 offen offset:2048 lds
    s_add_u32 m0, s46, 132096
    s_add_u32 s36, s36, 393216
    buffer_load_dwordx4 v15, s[8:11], s37 offen lds
    s_add_u32 s37, s37, 64
    s_add_u32 s59, s59, 1
    s_and_b32 s59, s59, 7
    v_mfma_f32_16x16x32_bf16 v[56:59], v[220:223], v[164:167], v[56:59]
    ds_read_b64_tr_b16 v[208:209], v16 offset:49152
    v_mfma_f32_16x16x32_bf16 v[92:95], v[224:227], v[164:167], v[92:95]
    v_mfma_f32_16x16x32_bf16 v[128:131], v[228:231], v[164:167], v[128:131]
    ds_read_b128 v[164:167], v22 offset:18432
    v_mfma_f32_16x16x32_bf16 v[60:63], v[220:223], v[168:171], v[60:63]
    ds_read_b64_tr_b16 v[210:211], v17 offset:49152
    v_mfma_f32_16x16x32_bf16 v[96:99], v[224:227], v[168:171], v[96:99]
    v_mfma_f32_16x16x32_bf16 v[132:135], v[228:231], v[168:171], v[132:135]
    ds_read_b128 v[168:171], v22 offset:19456
    v_mfma_f32_16x16x32_bf16 v[64:67], v[220:223], v[172:175], v[64:67]
    ds_read_b64_tr_b16 v[212:213], v18 offset:49152
    v_mfma_f32_16x16x32_bf16 v[100:103], v[224:227], v[172:175], v[100:103]
    v_mfma_f32_16x16x32_bf16 v[136:139], v[228:231], v[172:175], v[136:139]
    ds_read_b128 v[172:175], v22 offset:20480
    v_mfma_f32_16x16x32_bf16 v[68:71], v[220:223], v[176:179], v[68:71]
    ds_read_b64_tr_b16 v[214:215], v19 offset:49152
    v_mfma_f32_16x16x32_bf16 v[104:107], v[224:227], v[176:179], v[104:107]
    v_mfma_f32_16x16x32_bf16 v[140:143], v[228:231], v[176:179], v[140:143]
    ds_read_b128 v[176:179], v22 offset:21504
    v_mfma_f32_16x16x32_bf16 v[72:75], v[220:223], v[180:183], v[72:75]
    ds_read_b64_tr_b16 v[216:217], v20 offset:49152
    v_mfma_f32_16x16x32_bf16 v[108:111], v[224:227], v[180:183], v[108:111]
    v_mfma_f32_16x16x32_bf16 v[144:147], v[228:231], v[180:183], v[144:147]
    ds_read_b128 v[180:183], v22 offset:22528
    v_mfma_f32_16x16x32_bf16 v[76:79], v[220:223], v[184:187], v[76:79]
    ds_read_b64_tr_b16 v[218:219], v21 offset:49152
    v_mfma_f32_16x16x32_bf16 v[112:115], v[224:227], v[184:187], v[112:115]
    v_mfma_f32_16x16x32_bf16 v[148:151], v[228:231], v[184:187], v[148:151]
    ds_read_b128 v[184:187], v22 offset:23552
    v_mfma_f32_16x16x32_bf16 v[80:83], v[220:223], v[188:191], v[80:83]
    ds_read_b128 v[192:195], v22 offset:25600
    v_mfma_f32_16x16x32_bf16 v[116:119], v[224:227], v[188:191], v[116:119]
    v_mfma_f32_16x16x32_bf16 v[152:155], v[228:231], v[188:191], v[152:155]
    ds_read_b128 v[188:191], v22 offset:24576
    v_mfma_f32_16x16x32_bf16 v[84:87], v[220:223], v[200:203], v[84:87]
    ds_read_b128 v[196:199], v22 offset:26624
    v_mfma_f32_16x16x32_bf16 v[120:123], v[224:227], v[200:203], v[120:123]
    v_mfma_f32_16x16x32_bf16 v[156:159], v[228:231], v[200:203], v[156:159]
    v_mfma_f32_16x16x32_bf16 v[88:91], v[220:223], v[204:207], v[88:91]
    v_mfma_f32_16x16x32_bf16 v[124:127], v[224:227], v[204:207], v[124:127]
    v_mfma_f32_16x16x32_bf16 v[160:163], v[228:231], v[204:207], v[160:163]
    s_waitcnt lgkmcnt(0)
    s_waitcnt vmcnt(4)
    s_barrier
    s_cmp_lg_u32 s32, s59
    s_mov_b32 m0, 149504
    s_cbranch_scc1 KS_skip_1066
    buffer_load_dwordx4 v15, s[8:11], s38 offen lds
KS_skip_1066:
    s_add_u32 m0, s45, 98304
    s_add_u32 s38, s38, 64
    buffer_load_dwordx4 v12, s[12:15], s36 offen lds
    buffer_load_dwordx4 v13, s[12:15], s36 offen offset:1024 lds
    buffer_load_dwordx4 v14, s[12:15], s36 offen offset:2048 lds
    s_add_u32 m0, s46, 141312
    s_add_u32 s36, s36, 393216
    buffer_load_dwordx4 v15, s[8:11], s37 offen lds
    s_add_u32 s37, s37, 64
    s_add_u32 s59, s59, 1
    s_and_b32 s59, s59, 7
    v_mfma_f32_16x16x32_bf16 v[56:59], v[208:211], v[164:167], v[56:59]
    ds_read_b64_tr_b16 v[220:221], v16 offset:0
    v_mfma_f32_16x16x32_bf16 v[92:95], v[212:215], v[164:167], v[92:95]
    v_mfma_f32_16x16x32_bf16 v[128:131], v[216:219], v[164:167], v[128:131]
    ds_read_b128 v[164:167], v22 offset:0
    v_mfma_f32_16x16x32_bf16 v[60:63], v[208:211], v[168:171], v[60:63]
    ds_read_b64_tr_b16 v[222:223], v17 offset:0
    v_mfma_f32_16x16x32_bf16 v[96:99], v[212:215], v[168:171], v[96:99]
    v_mfma_f32_16x16x32_bf16 v[132:135], v[216:219], v[168:171], v[132:135]
    ds_read_b128 v[168:171], v22 offset:1024
    v_mfma_f32_16x16x32_bf16 v[64:67], v[208:211], v[172:175], v[64:67]
    ds_read_b64_tr_b16 v[224:225], v18 offset:0
    v_mfma_f32_16x16x32_bf16 v[100:103], v[212:215], v[172:175], v[100:103]
    v_mfma_f32_16x16x32_bf16 v[136:139], v[216:219], v[172:175], v[136:139]
    ds_read_b128 v[172:175], v22 offset:2048
    v_mfma_f32_16x16x32_bf16 v[68:71], v[208:211], v[176:179], v[68:71]
    ds_read_b64_tr_b16 v[226:227], v19 offset:0
    v_mfma_f32_16x16x32_bf16 v[104:107], v[212:215], v[176:179], v[104:107]
    v_mfma_f32_16x16x32_bf16 v[140:143], v[216:219], v[176:179], v[140:143]
    ds_read_b128 v[176:179], v22 offset:3072
    v_mfma_f32_16x16x32_bf16 v[72:75], v[208:211], v[180:183], v[72:75]
    ds_read_b64_tr_b16 v[228:229], v20 offset:0
    v_mfma_f32_16x16x32_bf16 v[108:111], v[212:215], v[180:183], v[108:111]
    v_mfma_f32_16x16x32_bf16 v[144:147], v[216:219], v[180:183], v[144:147]
    ds_read_b128 v[180:183], v22 offset:4096
    v_mfma_f32_16x16x32_bf16 v[76:79], v[208:211], v[184:187], v[76:79]
    ds_read_b64_tr_b16 v[230:231], v21 offset:0
    v_mfma_f32_16x16x32_bf16 v[112:115], v[212:215], v[184:187], v[112:115]
    v_mfma_f32_16x16x32_bf16 v[148:151], v[216:219], v[184:187], v[148:151]
    ds_read_b128 v[184:187], v22 offset:5120
    v_mfma_f32_16x16x32_bf16 v[80:83], v[208:211], v[188:191], v[80:83]
    ds_read_b128 v[200:203], v22 offset:7168
    v_mfma_f32_16x16x32_bf16 v[116:119], v[212:215], v[188:191], v[116:119]
    v_mfma_f32_16x16x32_bf16 v[152:155], v[216:219], v[188:191], v[152:155]
    ds_read_b128 v[188:191], v22 offset:6144
    v_mfma_f32_16x16x32_bf16 v[84:87], v[208:211], v[192:195], v[84:87]
    ds_read_b128 v[204:207], v22 offset:8192
    v_mfma_f32_16x16x32_bf16 v[120:123], v[212:215], v[192:195], v[120:123]
    v_mfma_f32_16x16x32_bf16 v[156:159], v[216:219], v[192:195], v[156:159]
    v_mfma_f32_16x16x32_bf16 v[88:91], v[208:211], v[196:199], v[88:91]
    v_mfma_f32_16x16x32_bf16 v[124:127], v[212:215], v[196:199], v[124:127]
    v_mfma_f32_16x16x32_bf16 v[160:163], v[216:219], v[196:199], v[160:163]
    s_waitcnt lgkmcnt(0)
    s_waitcnt vmcnt(4)
    s_barrier
    s_cmp_lg_u32 s32, s59
    s_mov_b32 m0, 131072
    s_cbranch_scc1 KS_skip_1067
    buffer_load_dwordx4 v15, s[8:11], s38 offen lds
KS_skip_1067:
    s_add_u32 m0, s45, 49152
    s_add_u32 s38, s38, 64
    buffer_load_dwordx4 v12, s[12:15], s36 offen lds
    buffer_load_dwordx4 v13, s[12:15], s36 offen offset:1024 lds
    buffer_load_dwordx4 v14, s[12:15], s36 offen offset:2048 lds
    s_add_u32 m0, s46, 122880
    s_add_u32 s36, s36, 393216
    buffer_load_dwordx4 v15, s[8:11], s37 offen lds
    s_add_u32 s37, s37, 64
    s_add_u32 s59, s59, 1
    s_and_b32 s59, s59, 7
    v_mfma_f32_16x16x32_bf16 v[56:59], v[220:223], v[164:167], v[56:59]
    ds_read_b64_tr_b16 v[208:209], v16 offset:24576
    v_mfma_f32_16x16x32_bf16 v[92:95], v[224:227], v[164:167], v[92:95]
    v_mfma_f32_16x16x32_bf16 v[128:131], v[228:231], v[164:167], v[128:131]
    ds_read_b128 v[164:167], v22 offset:9216
    v_mfma_f32_16x16x32_bf16 v[60:63], v[220:223], v[168:171], v[60:63]
    ds_read_b64_tr_b16 v[210:211], v17 offset:24576
    v_mfma_f32_16x16x32_bf16 v[96:99], v[224:227], v[168:171], v[96:99]
    v_mfma_f32_16x16x32_bf16 v[132:135], v[228:231], v[168:171], v[132:135]
    ds_read_b128 v[168:171], v22 offset:10240
    v_mfma_f32_16x16x32_bf16 v[64:67], v[220:223], v[172:175], v[64:67]
    ds_read_b64_tr_b16 v[212:213], v18 offset:24576
    v_mfma_f32_16x16x32_bf16 v[100:103], v[224:227], v[172:175], v[100:103]
    v_mfma_f32_16x16x32_bf16 v[136:139], v[228:231], v[172:175], v[136:139]
    ds_read_b128 v[172:175], v22 offset:11264
    v_mfma_f32_16x16x32_bf16 v[68:71], v[220:223], v[176:179], v[68:71]
    ds_read_b64_tr_b16 v[214:215], v19 offset:24576
    v_mfma_f32_16x16x32_bf16 v[104:107], v[224:227], v[176:179], v[104:107]
    v_mfma_f32_16x16x32_bf16 v[140:143], v[228:231], v[176:179], v[140:143]
    ds_read_b128 v[176:179], v22 offset:12288
    v_mfma_f32_16x16x32_bf16 v[72:75], v[220:223], v[180:183], v[72:75]
    ds_read_b64_tr_b16 v[216:217], v20 offset:24576
    v_mfma_f32_16x16x32_bf16 v[108:111], v[224:227], v[180:183], v[108:111]
    v_mfma_f32_16x16x32_bf16 v[144:147], v[228:231], v[180:183], v[144:147]
    ds_read_b128 v[180:183], v22 offset:13312
    v_mfma_f32_16x16x32_bf16 v[76:79], v[220:223], v[184:187], v[76:79]
    ds_read_b64_tr_b16 v[218:219], v21 offset:24576
    v_mfma_f32_16x16x32_bf16 v[112:115], v[224:227], v[184:187], v[112:115]
    v_mfma_f32_16x16x32_bf16 v[148:151], v[228:231], v[184:187], v[148:151]
    ds_read_b128 v[184:187], v22 offset:14336
    v_mfma_f32_16x16x32_bf16 v[80:83], v[220:223], v[188:191], v[80:83]
    ds_read_b128 v[192:195], v22 offset:16384
    v_mfma_f32_16x16x32_bf16 v[116:119], v[224:227], v[188:191], v[116:119]
    v_mfma_f32_16x16x32_bf16 v[152:155], v[228:231], v[188:191], v[152:155]
    ds_read_b128 v[188:191], v22 offset:15360
    v_mfma_f32_16x16x32_bf16 v[84:87], v[220:223], v[200:203], v[84:87]
    ds_read_b128 v[196:199], v22 offset:17408
    v_mfma_f32_16x16x32_bf16 v[120:123], v[224:227], v[200:203], v[120:123]
    v_mfma_f32_16x16x32_bf16 v[156:159], v[228:231], v[200:203], v[156:159]
    v_mfma_f32_16x16x32_bf16 v[88:91], v[220:223], v[204:207], v[88:91]
    v_mfma_f32_16x16x32_bf16 v[124:127], v[224:227], v[204:207], v[124:127]
    v_mfma_f32_16x16x32_bf16 v[160:163], v[228:231], v[204:207], v[160:163]
    s_waitcnt lgkmcnt(0)
    s_waitcnt vmcnt(4)
    s_barrier
    s_cmp_lg_u32 s32, s59
    s_mov_b32 m0, 140288
    s_cbranch_scc1 KS_skip_1068
    buffer_load_dwordx4 v15, s[8:11], s38 offen lds
KS_skip_1068:
    s_add_u32 m0, s45, 73728
    s_add_u32 s38, s38, 64
    buffer_load_dwordx4 v12, s[12:15], s36 offen lds
    buffer_load_dwordx4 v13, s[12:15], s36 offen offset:1024 lds
    buffer_load_dwordx4 v14, s[12:15], s36 offen offset:2048 lds
    s_add_u32 m0, s46, 132096
    s_add_u32 s36, s36, 393216
    buffer_load_dwordx4 v15, s[8:11], s37 offen lds
    s_add_u32 s37, s37, 64
    s_add_u32 s59, s59, 1
    s_and_b32 s59, s59, 7
    v_mfma_f32_16x16x32_bf16 v[56:59], v[208:211], v[164:167], v[56:59]
    ds_read_b64_tr_b16 v[220:221], v16 offset:49152
    v_mfma_f32_16x16x32_bf16 v[92:95], v[212:215], v[164:167], v[92:95]
    v_mfma_f32_16x16x32_bf16 v[128:131], v[216:219], v[164:167], v[128:131]
    ds_read_b128 v[164:167], v22 offset:18432
    v_mfma_f32_16x16x32_bf16 v[60:63], v[208:211], v[168:171], v[60:63]
    ds_read_b64_tr_b16 v[222:223], v17 offset:49152
    v_mfma_f32_16x16x32_bf16 v[96:99], v[212:215], v[168:171], v[96:99]
    v_mfma_f32_16x16x32_bf16 v[132:135], v[216:219], v[168:171], v[132:135]
    ds_read_b128 v[168:171], v22 offset:19456
    v_mfma_f32_16x16x32_bf16 v[64:67], v[208:211], v[172:175], v[64:67]
    ds_read_b64_tr_b16 v[224:225], v18 offset:49152
    v_mfma_f32_16x16x32_bf16 v[100:103], v[212:215], v[172:175], v[100:103]
    v_mfma_f32_16x16x32_bf16 v[136:139], v[216:219], v[172:175], v[136:139]
    ds_read_b128 v[172:175], v22 offset:20480
    v_mfma_f32_16x16x32_bf16 v[68:71], v[208:211], v[176:179], v[68:71]
    ds_read_b64_tr_b16 v[226:227], v19 offset:49152
    v_mfma_f32_16x16x32_bf16 v[104:107], v[212:215], v[176:179], v[104:107]
    v_mfma_f32_16x16x32_bf16 v[140:143], v[216:219], v[176:179], v[140:143]
    ds_read_b128 v[176:179], v22 offset:21504
    v_mfma_f32_16x16x32_bf16 v[72:75], v[208:211], v[180:183], v[72:75]
    ds_read_b64_tr_b16 v[228:229], v20 offset:49152
    v_mfma_f32_16x16x32_bf16 v[108:111], v[212:215], v[180:183], v[108:111]
    v_mfma_f32_16x16x32_bf16 v[144:147], v[216:219], v[180:183], v[144:147]
    ds_read_b128 v[180:183], v22 offset:22528
    v_mfma_f32_16x16x32_bf16 v[76:79], v[208:211], v[184:187], v[76:79]
    ds_read_b64_tr_b16 v[230:231], v21 offset:49152
    v_mfma_f32_16x16x32_bf16 v[112:115], v[212:215], v[184:187], v[112:115]
    v_mfma_f32_16x16x32_bf16 v[148:151], v[216:219], v[184:187], v[148:151]
    ds_read_b128 v[184:187], v22 offset:23552
    v_mfma_f32_16x16x32_bf16 v[80:83], v[208:211], v[188:191], v[80:83]
    ds_read_b128 v[200:203], v22 offset:25600
    v_mfma_f32_16x16x32_bf16 v[116:119], v[212:215], v[188:191], v[116:119]
    v_mfma_f32_16x16x32_bf16 v[152:155], v[216:219], v[188:191], v[152:155]
    ds_read_b128 v[188:191], v22 offset:24576
    v_mfma_f32_16x16x32_bf16 v[84:87], v[208:211], v[192:195], v[84:87]
    ds_read_b128 v[204:207], v22 offset:26624
    v_mfma_f32_16x16x32_bf16 v[120:123], v[212:215], v[192:195], v[120:123]
    v_mfma_f32_16x16x32_bf16 v[156:159], v[216:219], v[192:195], v[156:159]
    v_mfma_f32_16x16x32_bf16 v[88:91], v[208:211], v[196:199], v[88:91]
    v_mfma_f32_16x16x32_bf16 v[124:127], v[212:215], v[196:199], v[124:127]
    v_mfma_f32_16x16x32_bf16 v[160:163], v[216:219], v[196:199], v[160:163]
    s_waitcnt lgkmcnt(0)
    s_waitcnt vmcnt(4)
    s_barrier
    s_cmp_eq_u32 s57, 2
    s_cbranch_scc1 KS_wo_1070
    s_cmp_lg_u32 s32, s59
    s_mov_b32 m0, 149504
    s_cbranch_scc1 KS_skip_1069
    buffer_load_dwordx4 v15, s[8:11], s38 offen lds
KS_skip_1069:
    s_add_u32 m0, s45, 98304
    s_add_u32 s38, s38, 64
    buffer_load_dwordx4 v12, s[12:15], s36 offen lds
    buffer_load_dwordx4 v13, s[12:15], s36 offen offset:1024 lds
    buffer_load_dwordx4 v14, s[12:15], s36 offen offset:2048 lds
    s_add_u32 m0, s46, 141312
    s_add_u32 s36, s36, 393216
    buffer_load_dwordx4 v15, s[8:11], s37 offen lds
    s_add_u32 s37, s37, 64
    s_add_u32 s59, s59, 1
    s_and_b32 s59, s59, 7
KS_wo_1071:
    v_mfma_f32_16x16x32_bf16 v[56:59], v[220:223], v[164:167], v[56:59]
    ds_read_b64_tr_b16 v[208:209], v16 offset:0
    v_mfma_f32_16x16x32_bf16 v[92:95], v[224:227], v[164:167], v[92:95]
    v_mfma_f32_16x16x32_bf16 v[128:131], v[228:231], v[164:167], v[128:131]
    ds_read_b128 v[164:167], v22 offset:0
    v_mfma_f32_16x16x32_bf16 v[60:63], v[220:223], v[168:171], v[60:63]
    ds_read_b64_tr_b16 v[210:211], v17 offset:0
    v_mfma_f32_16x16x32_bf16 v[96:99], v[224:227], v[168:171], v[96:99]
    v_mfma_f32_16x16x32_bf16 v[132:135], v[228:231], v[168:171], v[132:135]
    ds_read_b128 v[168:171], v22 offset:1024
    v_mfma_f32_16x16x32_bf16 v[64:67], v[220:223], v[172:175], v[64:67]
    ds_read_b64_tr_b16 v[212:213], v18 offset:0
    v_mfma_f32_16x16x32_bf16 v[100:103], v[224:227], v[172:175], v[100:103]
    v_mfma_f32_16x16x32_bf16 v[136:139], v[228:231], v[172:175], v[136:139]
    ds_read_b128 v[172:175], v22 offset:2048
    v_mfma_f32_16x16x32_bf16 v[68:71], v[220:223], v[176:179], v[68:71]
    ds_read_b64_tr_b16 v[214:215], v19 offset:0
    v_mfma_f32_16x16x32_bf16 v[104:107], v[224:227], v[176:179], v[104:107]
    v_mfma_f32_16x16x32_bf16 v[140:143], v[228:231], v[176:179], v[140:143]
    ds_read_b128 v[176:179], v22 offset:3072
    v_mfma_f32_16x16x32_bf16 v[72:75], v[220:223], v[180:183], v[72:75]
    ds_read_b64_tr_b16 v[216:217], v20 offset:0
    v_mfma_f32_16x16x32_bf16 v[108:111], v[224:227], v[180:183], v[108:111]
    v_mfma_f32_16x16x32_bf16 v[144:147], v[228:231], v[180:183], v[144:147]
    ds_read_b128 v[180:183], v22 offset:4096
    v_mfma_f32_16x16x32_bf16 v[76:79], v[220:223], v[184:187], v[76:79]
    ds_read_b64_tr_b16 v[218:219], v21 offset:0
    v_mfma_f32_16x16x32_bf16 v[112:115], v[224:227], v[184:187], v[112:115]
    v_mfma_f32_16x16x32_bf16 v[148:151], v[228:231], v[184:187], v[148:151]
    ds_read_b128 v[184:187], v22 offset:5120
    v_mfma_f32_16x16x32_bf16 v[80:83], v[220:223], v[188:191], v[80:83]
    ds_read_b128 v[192:195], v22 offset:7168
    v_mfma_f32_16x16x32_bf16 v[116:119], v[224:227], v[188:191], v[116:119]
    v_mfma_f32_16x16x32_bf16 v[152:155], v[228:231], v[188:191], v[152:155]
    ds_read_b128 v[188:191], v22 offset:6144
    v_mfma_f32_16x16x32_bf16 v[84:87], v[220:223], v[200:203], v[84:87]
    ds_read_b128 v[196:199], v22 offset:8192
    v_mfma_f32_16x16x32_bf16 v[120:123], v[224:227], v[200:203], v[120:123]
    v_mfma_f32_16x16x32_bf16 v[156:159], v[228:231], v[200:203], v[156:159]
    v_mfma_f32_16x16x32_bf16 v[88:91], v[220:223], v[204:207], v[88:91]
    v_mfma_f32_16x16x32_bf16 v[124:127], v[224:227], v[204:207], v[124:127]
    v_mfma_f32_16x16x32_bf16 v[160:163], v[228:231], v[204:207], v[160:163]
    s_waitcnt lgkmcnt(0)
    s_add_u32 s57, s57, 1
    s_cmp_lt_u32 s57, 3
    s_cbranch_scc1 k1_qpY
    s_waitcnt vmcnt(2)
    s_barrier
    v_mfma_f32_16x16x32_bf16 v[56:59], v[208:211], v[164:167], v[56:59]
    ds_read_b64_tr_b16 v[220:221], v16 offset:24576
    v_mfma_f32_16x16x32_bf16 v[92:95], v[212:215], v[164:167], v[92:95]
    v_mfma_f32_16x16x32_bf16 v[128:131], v[216:219], v[164:167], v[128:131]
    ds_read_b128 v[164:167], v22 offset:9216
    v_mfma_f32_16x16x32_bf16 v[60:63], v[208:211], v[168:171], v[60:63]
    ds_read_b64_tr_b16 v[222:223], v17 offset:24576
    v_mfma_f32_16x16x32_bf16 v[96:99], v[212:215], v[168:171], v[96:99]
    v_mfma_f32_16x16x32_bf16 v[132:135], v[216:219], v[168:171], v[132:135]
    ds_read_b128 v[168:171], v22 offset:10240
    v_mfma_f32_16x16x32_bf16 v[64:67], v[208:211], v[172:175], v[64:67]
    ds_read_b64_tr_b16 v[224:225], v18 offset:24576
    v_mfma_f32_16x16x32_bf16 v[100:103], v[212:215], v[172:175], v[100:103]
    v_mfma_f32_16x16x32_bf16 v[136:139], v[216:219], v[172:175], v[136:139]
    ds_read_b128 v[172:175], v22 offset:11264
    v_mfma_f32_16x16x32_bf16 v[68:71], v[208:211], v[176:179], v[68:71]
    ds_read_b64_tr_b16 v[226:227], v19 offset:24576
    v_mfma_f32_16x16x32_bf16 v[104:107], v[212:215], v[176:179], v[104:107]
    v_mfma_f32_16x16x32_bf16 v[140:143], v[216:219], v[176:179], v[140:143]
    ds_read_b128 v[176:179], v22 offset:12288
    v_mfma_f32_16x16x32_bf16 v[72:75], v[208:211], v[180:183], v[72:75]
    ds_read_b64_tr_b16 v[228:229], v20 offset:24576
    v_mfma_f32_16x16x32_bf16 v[108:111], v[212:215], v[180:183], v[108:111]
    v_mfma_f32_16x16x32_bf16 v[144:147], v[216:219], v[180:183], v[144:147]
    ds_read_b128 v[180:183], v22 offset:13312
    v_mfma_f32_16x16x32_bf16 v[76:79], v[208:211], v[184:187], v[76:79]
    ds_read_b64_tr_b16 v[230:231], v21 offset:24576
    v_mfma_f32_16x16x32_bf16 v[112:115], v[212:215], v[184:187], v[112:115]
    v_mfma_f32_16x16x32_bf16 v[148:151], v[216:219], v[184:187], v[148:151]
    ds_read_b128 v[184:187], v22 offset:14336
    v_mfma_f32_16x16x32_bf16 v[80:83], v[208:211], v[188:191], v[80:83]
    ds_read_b128 v[200:203], v22 offset:16384
    v_mfma_f32_16x16x32_bf16 v[116:119], v[212:215], v[188:191], v[116:119]
    v_mfma_f32_16x16x32_bf16 v[152:155], v[216:219], v[188:191], v[152:155]
    ds_read_b128 v[188:191], v22 offset:15360
    v_mfma_f32_16x16x32_bf16 v[84:87], v[208:211], v[192:195], v[84:87]
    ds_read_b128 v[204:207], v22 offset:17408
    v_mfma_f32_16x16x32_bf16 v[120:123], v[212:215], v[192:195], v[120:123]
    v_mfma_f32_16x16x32_bf16 v[156:159], v[216:219], v[192:195], v[156:159]
    v_mfma_f32_16x16x32_bf16 v[88:91], v[208:211], v[196:199], v[88:91]
    v_mfma_f32_16x16x32_bf16 v[124:127], v[212:215], v[196:199], v[124:127]
    v_mfma_f32_16x16x32_bf16 v[160:163], v[216:219], v[196:199], v[160:163]
    s_waitcnt lgkmcnt(0)
k1_qdone:
    s_barrier
    v_mov_b32 v20, v232
    v_mov_b32 v21, v233
    v_mov_b32 v22, v234
    v_and_b32 v1, 15, v0
    v_lshlrev_b32 v1, 4, v1
    v_lshrrev_b32 v2, 5, v0
    v_lshl_add_u32 v1, v2, 8, v1
    v_bfe_u32 v2, v0, 4, 1
    v_lshl_add_u32 v1, v2, 3, v1
    s_lshr_b32 s40, s32, 2
    s_mul_i32 s40, s40, 55296
    s_mul_i32 s41, s33, 1536
    s_add_u32 s40, s40, s41
    s_add_u32 s40, s40, 49152
    v_add_u32 v1, s40, v1
    v_mfma_f32_16x16x32_bf16 v[56:59], v[220:223], v[164:167], v[56:59]
    v_mfma_f32_16x16x32_bf16 v[92:95], v[224:227], v[164:167], v[92:95]
    v_mfma_f32_16x16x32_bf16 v[128:131], v[228:231], v[164:167], v[128:131]
    v_mfma_f32_16x16x32_bf16 v[60:63], v[220:223], v[168:171], v[60:63]
    v_mfma_f32_16x16x32_bf16 v[96:99], v[224:227], v[168:171], v[96:99]
    v_mfma_f32_16x16x32_bf16 v[132:135], v[228:231], v[168:171], v[132:135]
    v_mfma_f32_16x16x32_bf16 v[64:67], v[220:223], v[172:175], v[64:67]
    v_mfma_f32_16x16x32_bf16 v[100:103], v[224:227], v[172:175], v[100:103]
    v_mfma_f32_16x16x32_bf16 v[136:139], v[228:231], v[172:175], v[136:139]
    v_mfma_f32_16x16x32_bf16 v[68:71], v[220:223], v[176:179], v[68:71]
    v_mul_f32 v56, s35, v56
    v_mul_f32 v57, s35, v57
    v_mul_f32 v58, s35, v58
    v_mul_f32 v59, s35, v59
    v_cvt_pk_bf16_f32 v56, v56, v57
    v_cvt_pk_bf16_f32 v57, v58, v59
    ds_write_b64 v1, v[56:57] offset:0
    v_mfma_f32_16x16x32_bf16 v[104:107], v[224:227], v[176:179], v[104:107]
    v_mul_f32 v92, s35, v92
    v_mul_f32 v93, s35, v93
    v_mul_f32 v94, s35, v94
    v_mul_f32 v95, s35, v95
    v_cvt_pk_bf16_f32 v92, v92, v93
    v_cvt_pk_bf16_f32 v93, v94, v95
    ds_write_b64 v1, v[92:93] offset:512
    v_mfma_f32_16x16x32_bf16 v[140:143], v[228:231], v[176:179], v[140:143]
    v_mul_f32 v128, s35, v128
    v_mul_f32 v129, s35, v129
    v_mul_f32 v130, s35, v130
    v_mul_f32 v131, s35, v131
    v_cvt_pk_bf16_f32 v128, v128, v129
    v_cvt_pk_bf16_f32 v129, v130, v131
    ds_write_b64 v1, v[128:129] offset:1024
    v_mfma_f32_16x16x32_bf16 v[72:75], v[220:223], v[180:183], v[72:75]
    v_mul_f32 v60, s35, v60
    v_mul_f32 v61, s35, v61
    v_mul_f32 v62, s35, v62
    v_mul_f32 v63, s35, v63
    v_cvt_pk_bf16_f32 v60, v60, v61
    v_cvt_pk_bf16_f32 v61, v62, v63
    ds_write_b64 v1, v[60:61] offset:6144
    v_mfma_f32_16x16x32_bf16 v[108:111], v[224:227], v[180:183], v[108:111]
    v_mul_f32 v96, s35, v96
    v_mul_f32 v97, s35, v97
    v_mul_f32 v98, s35, v98
    v_mul_f32 v99, s35, v99
    v_cvt_pk_bf16_f32 v96, v96, v97
    v_cvt_pk_bf16_f32 v97, v98, v99
    ds_write_b64 v1, v[96:97] offset:6656
    v_mfma_f32_16x16x32_bf16 v[144:147], v[228:231], v[180:183], v[144:147]
    v_mul_f32 v132, s35, v132
    v_mul_f32 v133, s35, v133
    v_mul_f32 v134, s35, v134
    v_mul_f32 v135, s35, v135
    v_cvt_pk_bf16_f32 v132, v132, v133
    v_cvt_pk_bf16_f32 v133, v134, v135
    ds_write_b64 v1, v[132:133] offset:7168
    v_mfma_f32_16x16x32_bf16 v[76:79], v[220:223], v[184:187], v[76:79]
    v_mul_f32 v64, s35, v64
    v_mul_f32 v65, s35, v65
    v_mul_f32 v66, s35, v66
    v_mul_f32 v67, s35, v67
    v_cvt_pk_bf16_f32 v64, v64, v65
    v_cvt_pk_bf16_f32 v65, v66, v67
    ds_write_b64 v1, v[64:65] offset:12288
    v_mfma_f32_16x16x32_bf16 v[112:115], v[224:227], v[184:187], v[112:115]
    v_mul_f32 v100, s35, v100
    v_mul_f32 v101, s35, v101
    v_mul_f32 v102, s35, v102
    v_mul_f32 v103, s35, v103
    v_cvt_pk_bf16_f32 v100, v100, v101
    v_cvt_pk_bf16_f32 v101, v102, v103
    ds_write_b64 v1, v[100:101] offset:12800
    v_mfma_f32_16x16x32_bf16 v[148:151], v[228:231], v[184:187], v[148:151]
    v_mul_f32 v136, s35, v136
    v_mul_f32 v137, s35, v137
    v_mul_f32 v138, s35, v138
    v_mul_f32 v139, s35, v139
    v_cvt_pk_bf16_f32 v136, v136, v137
    v_cvt_pk_bf16_f32 v137, v138, v139
    ds_write_b64 v1, v[136:137] offset:13312
    v_mfma_f32_16x16x32_bf16 v[80:83], v[220:223], v[188:191], v[80:83]
    v_mul_f32 v68, s35, v68
    v_mul_f32 v69, s35, v69
    v_mul_f32 v70, s35, v70
    v_mul_f32 v71, s35, v71
    v_cvt_pk_bf16_f32 v68, v68, v69
    v_cvt_pk_bf16_f32 v69, v70, v71
    ds_write_b64 v1, v[68:69] offset:18432
    v_mfma_f32_16x16x32_bf16 v[116:119], v[224:227], v[188:191], v[116:119]
    v_mul_f32 v104, s35, v104
    v_mul_f32 v105, s35, v105
    v_mul_f32 v106, s35, v106
    v_mul_f32 v107, s35, v107
    v_cvt_pk_bf16_f32 v104, v104, v105
    v_cvt_pk_bf16_f32 v105, v106, v107
    ds_write_b64 v1, v[104:105] offset:18944
    v_mfma_f32_16x16x32_bf16 v[152:155], v[228:231], v[188:191], v[152:155]
    v_mul_f32 v140, s35, v140
    v_mul_f32 v141, s35, v141
    v_mul_f32 v142, s35, v142
    v_mul_f32 v143, s35, v143
    v_cvt_pk_bf16_f32 v140, v140, v141
    v_cvt_pk_bf16_f32 v141, v142, v143
    ds_write_b64 v1, v[140:141] offset:19456
    v_mfma_f32_16x16x32_bf16 v[84:87], v[220:223], v[200:203], v[84:87]
    v_mul_f32 v72, s35, v72
    v_mul_f32 v73, s35, v73
    v_mul_f32 v74, s35, v74
    v_mul_f32 v75, s35, v75
    v_cvt_pk_bf16_f32 v72, v72, v73
    v_cvt_pk_bf16_f32 v73, v74, v75
    ds_write_b64 v1, v[72:73] offset:24576
    v_mfma_f32_16x16x32_bf16 v[120:123], v[224:227], v[200:203], v[120:123]
    v_mul_f32 v108, s35, v108
    v_mul_f32 v109, s35, v109
    v_mul_f32 v110, s35, v110
    v_mul_f32 v111, s35, v111
    v_cvt_pk_bf16_f32 v108, v108, v109
    v_cvt_pk_bf16_f32 v109, v110, v111
    ds_write_b64 v1, v[108:109] offset:25088
    v_mfma_f32_16x16x32_bf16 v[156:159], v[228:231], v[200:203], v[156:159]
    v_mul_f32 v144, s35, v144
    v_mul_f32 v145, s35, v145
    v_mul_f32 v146, s35, v146
    v_mul_f32 v147, s35, v147
    v_cvt_pk_bf16_f32 v144, v144, v145
    v_cvt_pk_bf16_f32 v145, v146, v147
    ds_write_b64 v1, v[144:145] offset:25600
    v_mfma_f32_16x16x32_bf16 v[88:91], v[220:223], v[204:207], v[88:91]
    v_mul_f32 v76, s35, v76
    v_mul_f32 v77, s35, v77
    v_mul_f32 v78, s35, v78
    v_mul_f32 v79, s35, v79
    v_cvt_pk_bf16_f32 v76, v76, v77
    v_cvt_pk_bf16_f32 v77, v78, v79
    ds_write_b64 v1, v[76:77] offset:30720
    v_mfma_f32_16x16x32_bf16 v[124:127], v[224:227], v[204:207], v[124:127]
    v_mul_f32 v112, s35, v112
    v_mul_f32 v113, s35, v113
    v_mul_f32 v114, s35, v114
    v_mul_f32 v115, s35, v115
    v_cvt_pk_bf16_f32 v112, v112, v113
    v_cvt_pk_bf16_f32 v113, v114, v115
    ds_write_b64 v1, v[112:113] offset:31232
    v_mfma_f32_16x16x32_bf16 v[160:163], v[228:231], v[204:207], v[160:163]
    v_mul_f32 v148, s35, v148
    v_mul_f32 v149, s35, v149
    v_mul_f32 v150, s35, v150
    v_mul_f32 v151, s35, v151
    v_cvt_pk_bf16_f32 v148, v148, v149
    v_cvt_pk_bf16_f32 v149, v150, v151
    ds_write_b64 v1, v[148:149] offset:31744
    v_mul_f32 v80, s35, v80
    v_mul_f32 v81, s35, v81
    v_mul_f32 v82, s35, v82
    v_mul_f32 v83, s35, v83
    v_cvt_pk_bf16_f32 v80, v80, v81
    v_cvt_pk_bf16_f32 v81, v82, v83
    ds_write_b64 v1, v[80:81] offset:36864
    v_mul_f32 v116, s35, v116
    v_mul_f32 v117, s35, v117
    v_mul_f32 v118, s35, v118
    v_mul_f32 v119, s35, v119
    v_cvt_pk_bf16_f32 v116, v116, v117
    v_cvt_pk_bf16_f32 v117, v118, v119
    ds_write_b64 v1, v[116:117] offset:37376
    v_mul_f32 v152, s35, v152
    v_mul_f32 v153, s35, v153
    v_mul_f32 v154, s35, v154
    v_mul_f32 v155, s35, v155
    v_cvt_pk_bf16_f32 v152, v152, v153
    v_cvt_pk_bf16_f32 v153, v154, v155
    ds_write_b64 v1, v[152:153] offset:37888
    v_mul_f32 v84, s35, v84
    v_mul_f32 v85, s35, v85
    v_mul_f32 v86, s35, v86
    v_mul_f32 v87, s35, v87
    v_cvt_pk_bf16_f32 v84, v84, v85
    v_cvt_pk_bf16_f32 v85, v86, v87
    ds_write_b64 v1, v[84:85] offset:43008
    v_mul_f32 v120, s35, v120
    v_mul_f32 v121, s35, v121
    v_mul_f32 v122, s35, v122
    v_mul_f32 v123, s35, v123
    v_cvt_pk_bf16_f32 v120, v120, v121
    v_cvt_pk_bf16_f32 v121, v122, v123
    ds_write_b64 v1, v[120:121] offset:43520
    v_mul_f32 v156, s35, v156
    v_mul_f32 v157, s35, v157
    v_mul_f32 v158, s35, v158
    v_mul_f32 v159, s35, v159
    v_cvt_pk_bf16_f32 v156, v156, v157
    v_cvt_pk_bf16_f32 v157, v158, v159
    ds_write_b64 v1, v[156:157] offset:44032
    v_mul_f32 v88, s35, v88
    v_mul_f32 v89, s35, v89
    v_mul_f32 v90, s35, v90
    v_mul_f32 v91, s35, v91
    v_cvt_pk_bf16_f32 v88, v88, v89
    v_cvt_pk_bf16_f32 v89, v90, v91
    ds_write_b64 v1, v[88:89] offset:49152
    v_mul_f32 v124, s35, v124
    v_mul_f32 v125, s35, v125
    v_mul_f32 v126, s35, v126
    v_mul_f32 v127, s35, v127
    v_cvt_pk_bf16_f32 v124, v124, v125
    v_cvt_pk_bf16_f32 v125, v126, v127
    ds_write_b64 v1, v[124:125] offset:49664
    v_mul_f32 v160, s35, v160
    v_mul_f32 v161, s35, v161
    v_mul_f32 v162, s35, v162
    v_mul_f32 v163, s35, v163
    v_cvt_pk_bf16_f32 v160, v160, v161
    v_cvt_pk_bf16_f32 v161, v162, v163
    ds_write_b64 v1, v[160:161] offset:50176
    s_waitcnt lgkmcnt(0)
    s_barrier
    s_cmp_lg_u32 s32, 6
    s_cbranch_scc1 k1_nofl
    s_cmp_ge_u32 s2, 8
    s_cbranch_scc1 k1_nofl
    v_mov_b32 v3, 0
    v_mov_b32 v4, 1
    s_lshl_b32 s40, s2, 2
    s_mov_b64 exec, 1
    buffer_store_dword v4, v3, s[76:79], s40 offen sc1
    s_mov_b64 exec, -1
k1_nofl:
    s_lshr_b32 s40, s32, 2
    s_mul_i32 s40, s40, 55296
    s_min_u32 s41, s33, 2
    s_mul_i32 s41, s41, 18432
    s_add_u32 s40, s40, s41
    s_add_u32 s40, s40, 49152
    v_add_u32 v1, s40, v23
    s_cmp_eq_u32 s33, 3
    s_cbranch_scc1 noq_1072
    ds_read_b128 v[184:187], v1 offset:0
    ds_read_b128 v[188:191], v1 offset:1024
    ds_read_b128 v[192:195], v1 offset:2048
    ds_read_b128 v[196:199], v1 offset:3072
    ds_read_b128 v[200:203], v1 offset:4096
    ds_read_b128 v[204:207], v1 offset:5120
    ds_read_b128 v[208:211], v1 offset:6144
    ds_read_b128 v[212:215], v1 offset:7168
    ds_read_b128 v[216:219], v1 offset:8192
    ds_read_b128 v[220:223], v1 offset:9216
    ds_read_b128 v[224:227], v1 offset:10240
    ds_read_b128 v[228:231], v1 offset:11264
    ds_read_b128 v[232:235], v1 offset:12288
    ds_read_b128 v[236:239], v1 offset:13312
    ds_read_b128 v[240:243], v1 offset:14336
    ds_read_b128 v[244:247], v1 offset:15360
    ds_read_b128 v[248:251], v1 offset:16384
    ds_read_b128 v[252:255], v1 offset:17408
    s_waitcnt lgkmcnt(0)
noq_1072:
    s_cmp_ge_u32 s32, 4
    s_cselect_b32 s63, 8, 0
    s_cselect_b32 s53, 2, 0
    s_cselect_b32 s48, 2, 1
    s_mul_i32 s48, s48, 24576
    s_lshl_b32 s40, s33, 13
    s_add_u32 s48, s48, s40
    s_add_u32 s52, s40, 73728
    s_mul_i32 s40, s53, 24576
    s_mov_b32 s50, 0
    s_mov_b32 s92, 0
    s_mov_b32 s23, 0
    v_add_u32 v24, s40, v24
    v_add_u32 v25, s40, v25
    s_mov_b32 s54, 24576
    s_mov_b32 s55, 18432
    s_mov_b32 s56, 1280
    s_cmp_eq_u32 s33, 3
    s_cbranch_scc1 k1_h0
    s_cmp_ge_u32 s32, 4
    s_cbranch_scc1 k1_lb
    s_setprio 1
    s_branch k1_xbody
k1_xloop:
    s_barrier
k1_xbody:
    ds_read_b128 v[104:107], v24 offset:0
    ds_read_b128 v[108:111], v24 offset:6144
    ds_read_b128 v[112:115], v25 offset:0
    ds_read_b128 v[116:119], v25 offset:6144
    s_cmp_eq_u32 s50, s63
    s_cbranch_scc1 R_xinit
K_xinit:
    s_waitcnt lgkmcnt(3)
    v_mfma_f32_16x16x32_bf16 v[56:59], v[104:107], v[184:187], v[128:131]
    ds_read_b128 v[120:123], v24 offset:128
    v_mfma_f32_16x16x32_bf16 v[64:67], v[104:107], v[208:211], v[132:135]
    v_mfma_f32_16x16x32_bf16 v[72:75], v[104:107], v[232:235], v[136:139]
    s_waitcnt lgkmcnt(3)
    v_mfma_f32_16x16x32_bf16 v[60:63], v[108:111], v[184:187], v[128:131]
    ds_read_b128 v[124:127], v24 offset:6272
    v_mfma_f32_16x16x32_bf16 v[68:71], v[108:111], v[208:211], v[132:135]
    v_mfma_f32_16x16x32_bf16 v[76:79], v[108:111], v[232:235], v[136:139]
    s_waitcnt lgkmcnt(3)
    v_mfma_f32_16x16x32_bf16 v[56:59], v[112:115], v[188:191], v[56:59]
    ds_read_b128 v[104:107], v25 offset:128
    v_mfma_f32_16x16x32_bf16 v[64:67], v[112:115], v[212:215], v[64:67]
    v_mfma_f32_16x16x32_bf16 v[72:75], v[112:115], v[236:239], v[72:75]
    s_waitcnt lgkmcnt(3)
    v_mfma_f32_16x16x32_bf16 v[60:63], v[116:119], v[188:191], v[60:63]
    ds_read_b128 v[108:111], v25 offset:6272
    v_mfma_f32_16x16x32_bf16 v[68:71], v[116:119], v[212:215], v[68:71]
    v_mfma_f32_16x16x32_bf16 v[76:79], v[116:119], v[236:239], v[76:79]
    s_waitcnt lgkmcnt(3)
    v_mfma_f32_16x16x32_bf16 v[56:59], v[120:123], v[192:195], v[56:59]
    ds_read_b128 v[112:115], v24 offset:256
    v_mfma_f32_16x16x32_bf16 v[64:67], v[120:123], v[216:219], v[64:67]
    v_mfma_f32_16x16x32_bf16 v[72:75], v[120:123], v[240:243], v[72:75]
    s_waitcnt lgkmcnt(3)
    v_mfma_f32_16x16x32_bf16 v[60:63], v[124:127], v[192:195], v[60:63]
    ds_read_b128 v[116:119], v24 offset:6400
    v_mfma_f32_16x16x32_bf16 v[68:71], v[124:127], v[216:219], v[68:71]
    v_mfma_f32_16x16x32_bf16 v[76:79], v[124:127], v[240:243], v[76:79]
    s_waitcnt lgkmcnt(3)
    v_mfma_f32_16x16x32_bf16 v[56:59], v[104:107], v[196:199], v[56:59]
    ds_read_b128 v[120:123], v25 offset:256
    v_mfma_f32_16x16x32_bf16 v[64:67], v[104:107], v[220:223], v[64:67]
    v_mfma_f32_16x16x32_bf16 v[72:75], v[104:107], v[244:247], v[72:75]
    s_waitcnt lgkmcnt(3)
    v_mfma_f32_16x16x32_bf16 v[60:63], v[108:111], v[196:199], v[60:63]
    ds_read_b128 v[124:127], v25 offset:6400
    v_mfma_f32_16x16x32_bf16 v[68:71], v[108:111], v[220:223], v[68:71]
    v_mfma_f32_16x16x32_bf16 v[76:79], v[108:111], v[244:247], v[76:79]
    s_waitcnt lgkmcnt(3)
    v_mfma_f32_16x16x32_bf16 v[56:59], v[112:115], v[200:203], v[56:59]
    ds_read_b128 v[104:107], v24 offset:12288
    v_mfma_f32_16x16x32_bf16 v[64:67], v[112:115], v[224:227], v[64:67]
    v_mfma_f32_16x16x32_bf16 v[72:75], v[112:115], v[248:251], v[72:75]
    s_waitcnt lgkmcnt(3)
    v_mfma_f32_16x16x32_bf16 v[60:63], v[116:119], v[200:203], v[60:63]
    ds_read_b128 v[108:111], v24 offset:18432
    v_mfma_f32_16x16x32_bf16 v[68:71], v[116:119], v[224:227], v[68:71]
    v_mfma_f32_16x16x32_bf16 v[76:79], v[116:119], v[248:251], v[76:79]
    s_waitcnt lgkmcnt(3)
    v_mfma_f32_16x16x32_bf16 v[56:59], v[120:123], v[204:207], v[56:59]
    ds_read_b128 v[112:115], v25 offset:12288
    v_mfma_f32_16x16x32_bf16 v[64:67], v[120:123], v[228:231], v[64:67]
    v_mfma_f32_16x16x32_bf16 v[72:75], v[120:123], v[252:255], v[72:75]
    s_waitcnt lgkmcnt(3)
    v_mfma_f32_16x16x32_bf16 v[60:63], v[124:127], v[204:207], v[60:63]
    ds_read_b128 v[116:119], v25 offset:18432
    v_mfma_f32_16x16x32_bf16 v[68:71], v[124:127], v[228:231], v[68:71]
    v_mfma_f32_16x16x32_bf16 v[76:79], v[124:127], v[252:255], v[76:79]
    s_waitcnt lgkmcnt(3)
    v_mfma_f32_16x16x32_bf16 v[80:83], v[104:107], v[184:187], v[128:131]
    ds_read_b128 v[120:123], v24 offset:12416
    v_mfma_f32_16x16x32_bf16 v[88:91], v[104:107], v[208:211], v[132:135]
    v_mfma_f32_16x16x32_bf16 v[96:99], v[104:107], v[232:235], v[136:139]
    s_waitcnt lgkmcnt(3)
    v_mfma_f32_16x16x32_bf16 v[84:87], v[108:111], v[184:187], v[128:131]
    ds_read_b128 v[124:127], v24 offset:18560
    v_mfma_f32_16x16x32_bf16 v[92:95], v[108:111], v[208:211], v[132:135]
    v_mfma_f32_16x16x32_bf16 v[100:103], v[108:111], v[232:235], v[136:139]
    s_cmp_lg_u32 s50, 0
    s_cbranch_scc1 KS_b_1073
    s_barrier
KS_b_1073:
    s_waitcnt lgkmcnt(3)
    v_mfma_f32_16x16x32_bf16 v[80:83], v[112:115], v[188:191], v[80:83]
    ds_read_b128 v[104:107], v25 offset:12416
    v_exp_f32 v48, v56
    v_exp_f32 v49, v57
    v_mfma_f32_16x16x32_bf16 v[88:91], v[112:115], v[212:215], v[88:91]
    v_exp_f32 v50, v58
    v_exp_f32 v51, v59
    v_mfma_f32_16x16x32_bf16 v[96:99], v[112:115], v[236:239], v[96:99]
    v_exp_f32 v52, v60
    v_exp_f32 v53, v61
    v_exp_f32 v54, v62
    s_waitcnt lgkmcnt(3)
    v_mfma_f32_16x16x32_bf16 v[84:87], v[116:119], v[188:191], v[84:87]
    ds_read_b128 v[108:111], v25 offset:18560
    v_exp_f32 v55, v63
    v_cvt_pk_bf16_f32 v140, v48, v49
    v_mfma_f32_16x16x32_bf16 v[92:95], v[116:119], v[212:215], v[92:95]
    v_cvt_pk_bf16_f32 v141, v50, v51
    v_cvt_pk_bf16_f32 v142, v52, v53
    v_cvt_pk_bf16_f32 v143, v54, v55
    v_mfma_f32_16x16x32_bf16 v[100:103], v[116:119], v[236:239], v[100:103]
    ds_write_b128 v29, v[140:143] offset:0
    v_add_f32 v48, v48, v52
    s_waitcnt lgkmcnt(4)
    v_mfma_f32_16x16x32_bf16 v[80:83], v[120:123], v[192:195], v[80:83]
    ds_read_b128 v[112:115], v24 offset:12544
    v_add_f32 v49, v49, v53
    v_add_f32 v50, v50, v54
    v_add_f32 v51, v51, v55
    v_mfma_f32_16x16x32_bf16 v[88:91], v[120:123], v[216:219], v[88:91]
    v_add_f32 v48, v48, v49
    v_add_f32 v50, v50, v51
    v_mfma_f32_16x16x32_bf16 v[96:99], v[120:123], v[240:243], v[96:99]
    v_add_f32 v39, v48, v50
    v_exp_f32 v148, v64
    v_exp_f32 v149, v65
    s_waitcnt lgkmcnt(4)
    v_mfma_f32_16x16x32_bf16 v[84:87], v[124:127], v[192:195], v[84:87]
    ds_read_b128 v[116:119], v24 offset:18688
    v_exp_f32 v150, v66
    v_exp_f32 v151, v67
    v_mfma_f32_16x16x32_bf16 v[92:95], v[124:127], v[216:219], v[92:95]
    v_exp_f32 v152, v68
    v_exp_f32 v153, v69
    v_exp_f32 v154, v70
    v_mfma_f32_16x16x32_bf16 v[100:103], v[124:127], v[240:243], v[100:103]
    v_exp_f32 v155, v71
    v_cvt_pk_bf16_f32 v144, v148, v149
    s_waitcnt lgkmcnt(4)
    v_mfma_f32_16x16x32_bf16 v[80:83], v[104:107], v[196:199], v[80:83]
    ds_read_b128 v[120:123], v25 offset:12544
    v_cvt_pk_bf16_f32 v145, v150, v151
    v_cvt_pk_bf16_f32 v146, v152, v153
    v_cvt_pk_bf16_f32 v147, v154, v155
    v_mfma_f32_16x16x32_bf16 v[88:91], v[104:107], v[220:223], v[88:91]
    ds_write_b128 v29, v[144:147] offset:1024
    v_add_f32 v148, v148, v152
    v_mfma_f32_16x16x32_bf16 v[96:99], v[104:107], v[244:247], v[96:99]
    v_add_f32 v149, v149, v153
    v_add_f32 v150, v150, v154
    v_add_f32 v151, v151, v155
    s_waitcnt lgkmcnt(5)
    v_mfma_f32_16x16x32_bf16 v[84:87], v[108:111], v[196:199], v[84:87]
    ds_read_b128 v[124:127], v25 offset:18688
    v_add_f32 v148, v148, v149
    v_add_f32 v150, v150, v151
    v_mfma_f32_16x16x32_bf16 v[92:95], v[108:111], v[220:223], v[92:95]
    v_add_f32 v40, v148, v150
    v_exp_f32 v48, v72
    v_mfma_f32_16x16x32_bf16 v[100:103], v[108:111], v[244:247], v[100:103]
    v_exp_f32 v49, v73
    v_exp_f32 v50, v74
    v_exp_f32 v51, v75
    s_waitcnt lgkmcnt(4)
    v_mfma_f32_16x16x32_bf16 v[80:83], v[112:115], v[200:203], v[80:83]
    v_exp_f32 v52, v76
    v_exp_f32 v53, v77
    v_mfma_f32_16x16x32_bf16 v[88:91], v[112:115], v[224:227], v[88:91]
    v_exp_f32 v54, v78
    v_exp_f32 v55, v79
    v_cvt_pk_bf16_f32 v140, v48, v49
    v_mfma_f32_16x16x32_bf16 v[96:99], v[112:115], v[248:251], v[96:99]
    v_cvt_pk_bf16_f32 v141, v50, v51
    v_cvt_pk_bf16_f32 v142, v52, v53
    s_waitcnt lgkmcnt(3)
    v_mfma_f32_16x16x32_bf16 v[84:87], v[116:119], v[200:203], v[84:87]
    v_cvt_pk_bf16_f32 v143, v54, v55
    ds_write_b128 v29, v[140:143] offset:2048
    v_add_f32 v48, v48, v52
    v_mfma_f32_16x16x32_bf16 v[92:95], v[116:119], v[224:227], v[92:95]
    v_add_f32 v49, v49, v53
    v_add_f32 v50, v50, v54
    v_mfma_f32_16x16x32_bf16 v[100:103], v[116:119], v[248:251], v[100:103]
    v_add_f32 v51, v51, v55
    v_add_f32 v48, v48, v49
    v_add_f32 v50, v50, v51
    s_waitcnt lgkmcnt(3)
    v_mfma_f32_16x16x32_bf16 v[80:83], v[120:123], v[204:207], v[80:83]
    v_add_f32 v41, v48, v50
    v_max3_f32 v1, v39, v40, v41
    v_mfma_f32_16x16x32_bf16 v[88:91], v[120:123], v[228:231], v[88:91]
    v_mov_b32 v2, 1.0
    v_cmp_nle_f32 vcc, v1, v45
    v_min3_f32 v1, v39, v40, v41
    v_mfma_f32_16x16x32_bf16 v[96:99], v[120:123], v[252:255], v[96:99]
    v_mul_f32 v3, 0x37800000, v47
    v_cmp_lt_f32 s[98:99], v1, v3
    s_waitcnt lgkmcnt(1)
    v_mfma_f32_16x16x32_bf16 v[84:87], v[124:127], v[204:207], v[84:87]
    s_or_b64 vcc, vcc, s[98:99]
    s_cbranch_vccnz R_sm0
K_sm0:
    ds_write_b32 v31, v2 offset:0
    v_mfma_f32_16x16x32_bf16 v[92:95], v[124:127], v[228:231], v[92:95]
    v_mov_b32 v47, 0
    v_mov_b32 v46, 0
    v_mfma_f32_16x16x32_bf16 v[100:103], v[124:127], v[252:255], v[100:103]
    v_add_f32 v36, v36, v39
    v_add_f32 v37, v37, v40
    v_add_f32 v38, v38, v41
    s_add_u32 s53, s53, 1
    s_cmp_eq_u32 s53, 3
    s_cselect_b32 s53, 0, s53
    s_cselect_b32 s41, -2, 1
    s_mul_i32 s41, s41, 24576
    v_add_u32 v24, s41, v24
    v_add_u32 v25, s41, v25
    v_exp_f32 v48, v80
    v_exp_f32 v49, v81
    v_exp_f32 v50, v82
    v_exp_f32 v51, v83
    v_exp_f32 v52, v84
    v_exp_f32 v53, v85
    v_exp_f32 v54, v86
    v_exp_f32 v55, v87
    v_cvt_pk_bf16_f32 v140, v48, v49
    v_cvt_pk_bf16_f32 v141, v50, v51
    v_cvt_pk_bf16_f32 v142, v52, v53
    v_cvt_pk_bf16_f32 v143, v54, v55
    ds_write_b128 v29, v[140:143] offset:9216
    v_add_f32 v48, v48, v52
    v_add_f32 v49, v49, v53
    v_add_f32 v50, v50, v54
    v_add_f32 v51, v51, v55
    v_add_f32 v48, v48, v49
    v_add_f32 v50, v50, v51
    v_add_f32 v39, v48, v50
    v_exp_f32 v148, v88
    v_exp_f32 v149, v89
    v_exp_f32 v150, v90
    v_exp_f32 v151, v91
    v_exp_f32 v152, v92
    v_exp_f32 v153, v93
    v_exp_f32 v154, v94
    v_exp_f32 v155, v95
    v_cvt_pk_bf16_f32 v144, v148, v149
    v_cvt_pk_bf16_f32 v145, v150, v151
    v_cvt_pk_bf16_f32 v146, v152, v153
    v_cvt_pk_bf16_f32 v147, v154, v155
    ds_write_b128 v29, v[144:147] offset:10240
    v_add_f32 v148, v148, v152
    v_add_f32 v149, v149, v153
    v_add_f32 v150, v150, v154
    v_add_f32 v151, v151, v155
    v_add_f32 v148, v148, v149
    v_add_f32 v150, v150, v151
    v_add_f32 v40, v148, v150
    v_exp_f32 v48, v96
    v_exp_f32 v49, v97
    v_exp_f32 v50, v98
    v_exp_f32 v51, v99
    v_exp_f32 v52, v100
    v_exp_f32 v53, v101
    v_exp_f32 v54, v102
    v_exp_f32 v55, v103
    v_cvt_pk_bf16_f32 v140, v48, v49
    v_cvt_pk_bf16_f32 v141, v50, v51
    v_cvt_pk_bf16_f32 v142, v52, v53
    v_cvt_pk_bf16_f32 v143, v54, v55
    ds_write_b128 v29, v[140:143] offset:11264
    v_add_f32 v48, v48, v52
    v_add_f32 v49, v49, v53
    v_add_f32 v50, v50, v54
    v_add_f32 v51, v51, v55
    v_add_f32 v48, v48, v49
    v_add_f32 v50, v50, v51
    v_add_f32 v41, v48, v50
    v_max3_f32 v1, v39, v40, v41
    v_mov_b32 v2, 1.0
    v_cmp_nle_f32 vcc, v1, v45
    s_cbranch_vccnz R_sm1
K_sm1:
    ds_write_b32 v31, v2 offset:640
    v_add_f32 v36, v36, v39
    v_add_f32 v37, v37, v40
    v_add_f32 v38, v38, v41
    s_add_u32 s40, s63, 7
    s_cmp_eq_u32 s50, s40
    s_cbranch_scc1 R_xfin
K_xfin:
    s_sub_u32 s40, s50, 8
    s_cmp_lt_u32 s40, 4
    s_cbranch_scc1 R_xst
K_xst:
    v_add_u32 v29, s55, v29
    v_add_u32 v31, s56, v31
    s_sub_u32 s55, 0, s55
    s_sub_u32 s56, 0, s56
    s_add_u32 s50, s50, 1
    s_and_b32 s40, s50, 7
    s_waitcnt lgkmcnt(0)
    s_cbranch_scc1 k1_xloop
    s_setprio 0
    s_cmp_eq_u32 s50, 8
    s_cbranch_scc1 k1_lb
    s_barrier
    s_call_b64 s[60:61], op_pre
    s_call_b64 s[60:61], op_addr
    s_branch k1_attend
k1_lloop:
    s_cmp_lt_u32 s50, 15
    s_cbranch_scc1 k1_lw
    s_waitcnt vmcnt(0)
k1_lw:
    s_waitcnt vmcnt(8)
k1_lb:
    s_barrier
    s_cmp_eq_u32 s92, 8
    s_cbranch_scc1 k1_ly
    s_add_u32 s41, s50, 0
    s_add_u32 s40, s41, s43
    s_and_b32 s40, s40, 7
    s_mul_i32 s40, s40, 24576
    s_add_u32 s51, s40, s34
    s_cmp_ge_u32 s41, 8
    s_cselect_b32 s40, 3145728, 0
    s_add_u32 s51, s51, s40
    s_add_u32 m0, s52, 0
    s_add_u32 s40, s51, 0
    buffer_load_dwordx4 v9, s[16:19], s40 offen nt lds
    buffer_load_dwordx4 v10, s[16:19], s40 offen offset:1024 nt lds
    buffer_load_dwordx4 v11, s[16:19], s40 offen offset:2048 nt lds
    buffer_load_dwordx4 v20, s[16:19], s40 offen offset:3072 nt lds
    s_add_u32 m0, s52, 4096
    s_add_u32 s40, s51, 4096
    buffer_load_dwordx4 v21, s[16:19], s40 offen nt lds
    buffer_load_dwordx4 v22, s[16:19], s40 offen offset:1024 nt lds
    buffer_load_dwordx4 v9, s[16:19], s40 offen offset:2048 nt lds
    buffer_load_dwordx4 v10, s[16:19], s40 offen offset:3072 nt lds
    s_add_u32 s52, s52, 24576
    s_cmp_ge_u32 s52, 122880
    s_cselect_b32 s40, 49152, 0
    s_sub_u32 s52, s52, s40
    s_cmp_eq_u32 s92, 0
    s_cbranch_scc1 R_lz
k1_ly:
    ds_read_b128 v[48:51], v32 offset:0
    ds_read_b128 v[52:55], v32 offset:640
    ds_read_b64_tr_b16 v[160:161], v26 offset:0
    ds_read_b64_tr_b16 v[162:163], v26 offset:6144
    ds_read_b64_tr_b16 v[164:165], v26 offset:8
    ds_read_b64_tr_b16 v[166:167], v26 offset:6152
    ds_read_b128 v[128:131], v30 offset:0
    ds_read_b128 v[132:135], v30 offset:1024
    ds_read_b128 v[136:139], v30 offset:2048
    ds_read_b128 v[140:143], v30 offset:3072
    ds_read_b128 v[144:147], v30 offset:4096
    s_waitcnt lgkmcnt(10)
    v_min3_f32 v1, v48, v49, v50
    v_min_f32 v1, v1, v51
    v_cmp_gt_f32 vcc, 1.0, v1
    s_cbranch_vccnz R_rs20
K_rs20:
    s_waitcnt lgkmcnt(4)
    v_mfma_f32_16x16x32_bf16 v[56:59], v[160:163], v[128:131], v[56:59]
    ds_read_b128 v[148:151], v28 offset:5120
    v_mfma_f32_16x16x32_bf16 v[92:95], v[164:167], v[128:131], v[92:95]
    ds_read_b64_tr_b16 v[168:169], v26 offset:12288
    s_waitcnt lgkmcnt(5)
    v_mfma_f32_16x16x32_bf16 v[60:63], v[160:163], v[132:135], v[60:63]
    ds_read_b128 v[152:155], v28 offset:6144
    v_mfma_f32_16x16x32_bf16 v[96:99], v[164:167], v[132:135], v[96:99]
    ds_read_b64_tr_b16 v[170:171], v26 offset:18432
    s_waitcnt lgkmcnt(6)
    v_mfma_f32_16x16x32_bf16 v[64:67], v[160:163], v[136:139], v[64:67]
    ds_read_b128 v[128:131], v28 offset:7168
    v_mfma_f32_16x16x32_bf16 v[100:103], v[164:167], v[136:139], v[100:103]
    ds_read_b64_tr_b16 v[172:173], v26 offset:12296
    s_waitcnt lgkmcnt(7)
    v_mfma_f32_16x16x32_bf16 v[68:71], v[160:163], v[140:143], v[68:71]
    ds_read_b128 v[132:135], v28 offset:8192
    v_mfma_f32_16x16x32_bf16 v[104:107], v[164:167], v[140:143], v[104:107]
    ds_read_b64_tr_b16 v[174:175], v26 offset:18440
    s_waitcnt lgkmcnt(8)
    v_mfma_f32_16x16x32_bf16 v[72:75], v[160:163], v[144:147], v[72:75]
    ds_read_b128 v[136:139], v30 offset:9216
    v_mfma_f32_16x16x32_bf16 v[108:111], v[164:167], v[144:147], v[108:111]
    s_waitcnt lgkmcnt(8)
    v_mfma_f32_16x16x32_bf16 v[76:79], v[160:163], v[148:151], v[76:79]
    ds_read_b128 v[140:143], v30 offset:10240
    v_mfma_f32_16x16x32_bf16 v[112:115], v[164:167], v[148:151], v[112:115]
    s_waitcnt lgkmcnt(7)
    v_mfma_f32_16x16x32_bf16 v[80:83], v[160:163], v[152:155], v[80:83]
    ds_read_b128 v[144:147], v30 offset:11264
    v_mfma_f32_16x16x32_bf16 v[116:119], v[164:167], v[152:155], v[116:119]
    s_waitcnt lgkmcnt(6)
    v_mfma_f32_16x16x32_bf16 v[84:87], v[160:163], v[128:131], v[84:87]
    ds_read_b128 v[148:151], v30 offset:12288
    v_mfma_f32_16x16x32_bf16 v[120:123], v[164:167], v[128:131], v[120:123]
    s_waitcnt lgkmcnt(5)
    v_mfma_f32_16x16x32_bf16 v[88:91], v[160:163], v[132:135], v[88:91]
    ds_read_b128 v[152:155], v30 offset:13312
    v_mfma_f32_16x16x32_bf16 v[124:127], v[164:167], v[132:135], v[124:127]
    v_min3_f32 v1, v52, v53, v54
    v_min_f32 v1, v1, v55
    v_cmp_gt_f32 vcc, 1.0, v1
    s_cbranch_vccnz R_rs21
K_rs21:
    s_waitcnt lgkmcnt(4)
    v_mfma_f32_16x16x32_bf16 v[56:59], v[168:171], v[136:139], v[56:59]
    ds_read_b128 v[128:131], v28 offset:14336
    v_mfma_f32_16x16x32_bf16 v[92:95], v[172:175], v[136:139], v[92:95]
    s_waitcnt lgkmcnt(4)
    v_mfma_f32_16x16x32_bf16 v[60:63], v[168:171], v[140:143], v[60:63]
    ds_read_b128 v[132:135], v28 offset:15360
    v_mfma_f32_16x16x32_bf16 v[96:99], v[172:175], v[140:143], v[96:99]
    s_waitcnt lgkmcnt(4)
    v_mfma_f32_16x16x32_bf16 v[64:67], v[168:171], v[144:147], v[64:67]
    ds_read_b128 v[136:139], v28 offset:16384
    v_mfma_f32_16x16x32_bf16 v[100:103], v[172:175], v[144:147], v[100:103]
    s_waitcnt lgkmcnt(4)
    v_mfma_f32_16x16x32_bf16 v[68:71], v[168:171], v[148:151], v[68:71]
    ds_read_b128 v[140:143], v28 offset:17408
    v_mfma_f32_16x16x32_bf16 v[104:107], v[172:175], v[148:151], v[104:107]
    s_waitcnt lgkmcnt(4)
    v_mfma_f32_16x16x32_bf16 v[72:75], v[168:171], v[152:155], v[72:75]
    v_mfma_f32_16x16x32_bf16 v[108:111], v[172:175], v[152:155], v[108:111]
    s_waitcnt lgkmcnt(3)
    v_mfma_f32_16x16x32_bf16 v[76:79], v[168:171], v[128:131], v[76:79]
    v_mfma_f32_16x16x32_bf16 v[112:115], v[172:175], v[128:131], v[112:115]
    s_waitcnt lgkmcnt(2)
    v_mfma_f32_16x16x32_bf16 v[80:83], v[168:171], v[132:135], v[80:83]
    v_mfma_f32_16x16x32_bf16 v[116:119], v[172:175], v[132:135], v[116:119]
    s_waitcnt lgkmcnt(1)
    v_mfma_f32_16x16x32_bf16 v[84:87], v[168:171], v[136:139], v[84:87]
    v_mfma_f32_16x16x32_bf16 v[120:123], v[172:175], v[136:139], v[120:123]
    s_waitcnt lgkmcnt(0)
    v_mfma_f32_16x16x32_bf16 v[88:91], v[168:171], v[140:143], v[88:91]
    v_mfma_f32_16x16x32_bf16 v[124:127], v[172:175], v[140:143], v[124:127]
    s_and_b32 s40, s50, 7
    s_cmp_eq_u32 s40, 0
    s_cbranch_scc1 R_yfin2
K_yfin2:
    v_add_u32 v26, s54, v26
    v_add_u32 v27, s54, v27
    v_add_u32 v30, s55, v30
    v_add_u32 v28, s55, v28
    v_add_u32 v32, s56, v32
    v_add_u32 v33, s56, v33
    s_sub_u32 s54, 0, s54
    s_sub_u32 s55, 0, s55
    s_sub_u32 s56, 0, s56
    s_cmp_eq_u32 s92, 8
    s_cbranch_scc1 k1_lexit
k1_lk:
    s_cmp_ge_u32 s50, 14
    s_cbranch_scc1 k1_lnk
    s_add_u32 s41, s50, 2
    s_add_u32 s40, s41, s43
    s_and_b32 s40, s40, 7
    s_mul_i32 s40, s40, 24576
    s_add_u32 s51, s40, s34
    s_cmp_ge_u32 s41, 8
    s_cselect_b32 s40, 3145728, 0
    s_add_u32 s51, s51, s40
    s_add_u32 m0, s48, 0
    s_add_u32 s40, s51, 0
    buffer_load_dwordx4 v9, s[4:7], s40 offen nt lds
    buffer_load_dwordx4 v10, s[4:7], s40 offen offset:1024 nt lds
    buffer_load_dwordx4 v11, s[4:7], s40 offen offset:2048 nt lds
    buffer_load_dwordx4 v20, s[4:7], s40 offen offset:3072 nt lds
    s_add_u32 m0, s48, 4096
    s_add_u32 s40, s51, 4096
    buffer_load_dwordx4 v21, s[4:7], s40 offen nt lds
    buffer_load_dwordx4 v22, s[4:7], s40 offen offset:1024 nt lds
    buffer_load_dwordx4 v9, s[4:7], s40 offen offset:2048 nt lds
    buffer_load_dwordx4 v10, s[4:7], s40 offen offset:3072 nt lds
    s_add_u32 s48, s48, 24576
    s_cmp_ge_u32 s48, 73728
    s_cselect_b32 s40, 73728, 0
    s_sub_u32 s48, s48, s40
k1_lnk:
    s_cmp_lg_u32 s50, 12
    s_cbranch_scc1 k1_lna
    s_call_b64 s[60:61], op_addr
k1_lna:
    s_add_u32 s50, s50, 1
    s_add_u32 s92, s92, 1
    s_waitcnt lgkmcnt(0)
    s_branch k1_lloop
k1_lexit:
    s_cmp_eq_u32 s50, 16
    s_cbranch_scc1 k1_lfin
    s_setprio 1
    s_nop 7
    s_branch k1_xbody
k1_lfin:
    s_call_b64 s[60:61], op_pre
    s_lshr_b32 s40, s50, 4
    s_mul_i32 s40, s40, 7077888
    s_add_u32 s42, s40, s47
    s_lshr_b32 s41, s20, 1
    s_mul_i32 s41, s41, 147456
    s_and_b32 s40, s20, 1
    s_lshl_b32 s40, s40, 10
    s_add_u32 s40, s40, s41
    s_add_u32 s40, s40, s42
    v_add_u32 v1, s40, v35
    s_add_u32 s40, s42, 294912
    v_add_u32 v2, s40, v35
    buffer_store_dwordx4 v[156:159], v1, s[24:27], s69 offen sc1
    buffer_store_dwordx4 v[160:163], v1, s[24:27], s70 offen sc1
    buffer_store_dwordx4 v[164:167], v1, s[24:27], s71 offen sc1
    buffer_store_dwordx4 v[168:171], v1, s[24:27], s72 offen sc1
    buffer_store_dwordx4 v[172:175], v1, s[24:27], s73 offen sc1
    buffer_store_dwordx4 v[176:179], v1, s[24:27], s74 offen sc1
    buffer_store_dwordx4 v[180:183], v1, s[24:27], s75 offen sc1
    buffer_store_dwordx4 v[12:15], v1, s[24:27], s64 offen sc1
    buffer_store_dwordx4 v[16:19], v1, s[24:27], s65 offen sc1
    s_branch k1_attend
k1_h0:
    s_barrier
    v_mov_b32 v56, 0
    v_mov_b32 v57, 0
    v_mov_b32 v58, 0
    v_mov_b32 v59, 0
    v_mov_b32 v60, 0
    v_mov_b32 v61, 0
    v_mov_b32 v62, 0
    v_mov_b32 v63, 0
    v_mov_b32 v64, 0
    v_mov_b32 v65, 0
    v_mov_b32 v66, 0
    v_mov_b32 v67, 0
    v_mov_b32 v68, 0
    v_mov_b32 v69, 0
    v_mov_b32 v70, 0
    v_mov_b32 v71, 0
    v_mov_b32 v72, 0
    v_mov_b32 v73, 0
    v_mov_b32 v74, 0
    v_mov_b32 v75, 0
    v_mov_b32 v76, 0
    v_mov_b32 v77, 0
    v_mov_b32 v78, 0
    v_mov_b32 v79, 0
    v_mov_b32 v80, 0
    v_mov_b32 v81, 0
    v_mov_b32 v82, 0
    v_mov_b32 v83, 0
    v_mov_b32 v84, 0
    v_mov_b32 v85, 0
    v_mov_b32 v86, 0
    v_mov_b32 v87, 0
    v_mov_b32 v88, 0
    v_mov_b32 v89, 0
    v_mov_b32 v90, 0
    v_mov_b32 v91, 0
    v_mov_b32 v92, 0
    v_mov_b32 v93, 0
    v_mov_b32 v94, 0
    v_mov_b32 v95, 0
    v_mov_b32 v96, 0
    v_mov_b32 v97, 0
    v_mov_b32 v98, 0
    v_mov_b32 v99, 0
    v_mov_b32 v100, 0
    v_mov_b32 v101, 0
    v_mov_b32 v102, 0
    v_mov_b32 v103, 0
    v_mov_b32 v104, 0
    v_mov_b32 v105, 0
    v_mov_b32 v106, 0
    v_mov_b32 v107, 0
    v_mov_b32 v108, 0
    v_mov_b32 v109, 0
    v_mov_b32 v110, 0
    v_mov_b32 v111, 0
    v_mov_b32 v112, 0
    v_mov_b32 v113, 0
    v_mov_b32 v114, 0
    v_mov_b32 v115, 0
    v_mov_b32 v116, 0
    v_mov_b32 v117, 0
    v_mov_b32 v118, 0
    v_mov_b32 v119, 0
    v_mov_b32 v120, 0
    v_mov_b32 v121, 0
    v_mov_b32 v122, 0
    v_mov_b32 v123, 0
    v_mov_b32 v124, 0
    v_mov_b32 v125, 0
    v_mov_b32 v126, 0
    v_mov_b32 v127, 0
    v_mov_b32 v128, 0
    v_mov_b32 v129, 0
    v_mov_b32 v130, 0
    v_mov_b32 v131, 0
    v_mov_b32 v132, 0
    v_mov_b32 v133, 0
    v_mov_b32 v134, 0
    v_mov_b32 v135, 0
    v_mov_b32 v136, 0
    v_mov_b32 v137, 0
    v_mov_b32 v138, 0
    v_mov_b32 v139, 0
    v_mov_b32 v140, 0
    v_mov_b32 v141, 0
    v_mov_b32 v142, 0
    v_mov_b32 v143, 0
    v_mov_b32 v144, 0
    v_mov_b32 v145, 0
    v_mov_b32 v146, 0
    v_mov_b32 v147, 0
    v_mov_b32 v148, 0
    v_mov_b32 v149, 0
    v_mov_b32 v150, 0
    v_mov_b32 v151, 0
    v_mov_b32 v152, 0
    v_mov_b32 v153, 0
    v_mov_b32 v154, 0
    v_mov_b32 v155, 0
    v_mov_b32 v156, 0
    v_mov_b32 v157, 0
    v_mov_b32 v158, 0
    v_mov_b32 v159, 0
    v_mov_b32 v160, 0
    v_mov_b32 v161, 0
    v_mov_b32 v162, 0
    v_mov_b32 v163, 0
    v_mov_b32 v164, 0
    v_mov_b32 v165, 0
    v_mov_b32 v166, 0
    v_mov_b32 v167, 0
    s_mov_b32 s50, 1
k1_hloop:
    s_barrier
    ds_read_b128 v[48:51], v32 offset:0
    ds_read_b128 v[52:55], v32 offset:640
    ds_read_b64_tr_b16 v[200:201], v26 offset:0
    ds_read_b64_tr_b16 v[202:203], v26 offset:6144
    ds_read_b64_tr_b16 v[204:205], v26 offset:8
    ds_read_b64_tr_b16 v[206:207], v26 offset:6152
    ds_read_b64_tr_b16 v[208:209], v27 offset:0
    ds_read_b64_tr_b16 v[210:211], v27 offset:6144
    ds_read_b64_tr_b16 v[212:213], v27 offset:8
    ds_read_b64_tr_b16 v[214:215], v27 offset:6152
    ds_read_b128 v[168:171], v30 offset:0
    ds_read_b128 v[172:175], v30 offset:1024
    ds_read_b128 v[176:179], v30 offset:2048
    ds_read_b128 v[180:183], v30 offset:3072
    ds_read_b128 v[184:187], v30 offset:4096
    s_waitcnt lgkmcnt(14)
    v_min3_f32 v1, v48, v49, v50
    v_min_f32 v1, v1, v51
    v_cmp_gt_f32 vcc, 1.0, v1
    s_cbranch_vccnz R_rs30
K_rs30:
    s_waitcnt lgkmcnt(4)
    v_mfma_f32_16x16x32_bf16 v[56:59], v[200:203], v[168:171], v[56:59]
    ds_read_b128 v[188:191], v28 offset:5120
    v_mfma_f32_16x16x32_bf16 v[92:95], v[204:207], v[168:171], v[92:95]
    ds_read_b64_tr_b16 v[216:217], v26 offset:12288
    v_mfma_f32_16x16x32_bf16 v[128:131], v[208:211], v[168:171], v[128:131]
    v_mfma_f32_16x16x32_bf16 v[148:151], v[212:215], v[168:171], v[148:151]
    s_waitcnt lgkmcnt(5)
    v_mfma_f32_16x16x32_bf16 v[60:63], v[200:203], v[172:175], v[60:63]
    ds_read_b128 v[192:195], v28 offset:6144
    v_mfma_f32_16x16x32_bf16 v[96:99], v[204:207], v[172:175], v[96:99]
    ds_read_b64_tr_b16 v[218:219], v26 offset:18432
    v_mfma_f32_16x16x32_bf16 v[132:135], v[208:211], v[172:175], v[132:135]
    v_mfma_f32_16x16x32_bf16 v[152:155], v[212:215], v[172:175], v[152:155]
    s_waitcnt lgkmcnt(6)
    v_mfma_f32_16x16x32_bf16 v[64:67], v[200:203], v[176:179], v[64:67]
    ds_read_b128 v[168:171], v28 offset:7168
    v_mfma_f32_16x16x32_bf16 v[100:103], v[204:207], v[176:179], v[100:103]
    ds_read_b64_tr_b16 v[220:221], v26 offset:12296
    v_mfma_f32_16x16x32_bf16 v[136:139], v[208:211], v[176:179], v[136:139]
    v_mfma_f32_16x16x32_bf16 v[156:159], v[212:215], v[176:179], v[156:159]
    s_waitcnt lgkmcnt(7)
    v_mfma_f32_16x16x32_bf16 v[68:71], v[200:203], v[180:183], v[68:71]
    ds_read_b128 v[172:175], v28 offset:8192
    v_mfma_f32_16x16x32_bf16 v[104:107], v[204:207], v[180:183], v[104:107]
    ds_read_b64_tr_b16 v[222:223], v26 offset:18440
    v_mfma_f32_16x16x32_bf16 v[140:143], v[208:211], v[180:183], v[140:143]
    v_mfma_f32_16x16x32_bf16 v[160:163], v[212:215], v[180:183], v[160:163]
    s_waitcnt lgkmcnt(8)
    v_mfma_f32_16x16x32_bf16 v[72:75], v[200:203], v[184:187], v[72:75]
    ds_read_b128 v[176:179], v30 offset:9216
    v_mfma_f32_16x16x32_bf16 v[108:111], v[204:207], v[184:187], v[108:111]
    ds_read_b64_tr_b16 v[224:225], v27 offset:12288
    v_mfma_f32_16x16x32_bf16 v[144:147], v[208:211], v[184:187], v[144:147]
    v_mfma_f32_16x16x32_bf16 v[164:167], v[212:215], v[184:187], v[164:167]
    s_waitcnt lgkmcnt(9)
    v_mfma_f32_16x16x32_bf16 v[76:79], v[200:203], v[188:191], v[76:79]
    ds_read_b128 v[180:183], v30 offset:10240
    v_mfma_f32_16x16x32_bf16 v[112:115], v[204:207], v[188:191], v[112:115]
    ds_read_b64_tr_b16 v[226:227], v27 offset:18432
    s_waitcnt lgkmcnt(9)
    v_mfma_f32_16x16x32_bf16 v[80:83], v[200:203], v[192:195], v[80:83]
    ds_read_b128 v[184:187], v30 offset:11264
    v_mfma_f32_16x16x32_bf16 v[116:119], v[204:207], v[192:195], v[116:119]
    ds_read_b64_tr_b16 v[228:229], v27 offset:12296
    s_waitcnt lgkmcnt(9)
    v_mfma_f32_16x16x32_bf16 v[84:87], v[200:203], v[168:171], v[84:87]
    ds_read_b128 v[188:191], v30 offset:12288
    v_mfma_f32_16x16x32_bf16 v[120:123], v[204:207], v[168:171], v[120:123]
    ds_read_b64_tr_b16 v[230:231], v27 offset:18440
    s_waitcnt lgkmcnt(9)
    v_mfma_f32_16x16x32_bf16 v[88:91], v[200:203], v[172:175], v[88:91]
    ds_read_b128 v[192:195], v30 offset:13312
    v_mfma_f32_16x16x32_bf16 v[124:127], v[204:207], v[172:175], v[124:127]
    v_min3_f32 v1, v52, v53, v54
    v_min_f32 v1, v1, v55
    v_cmp_gt_f32 vcc, 1.0, v1
    s_cbranch_vccnz R_rs31
K_rs31:
    s_waitcnt lgkmcnt(8)
    v_mfma_f32_16x16x32_bf16 v[56:59], v[216:219], v[176:179], v[56:59]
    ds_read_b128 v[168:171], v28 offset:14336
    v_mfma_f32_16x16x32_bf16 v[92:95], v[220:223], v[176:179], v[92:95]
    s_waitcnt lgkmcnt(6)
    v_mfma_f32_16x16x32_bf16 v[128:131], v[224:227], v[176:179], v[128:131]
    s_waitcnt lgkmcnt(2)
    v_mfma_f32_16x16x32_bf16 v[148:151], v[228:231], v[176:179], v[148:151]
    v_mfma_f32_16x16x32_bf16 v[60:63], v[216:219], v[180:183], v[60:63]
    ds_read_b128 v[172:175], v28 offset:15360
    v_mfma_f32_16x16x32_bf16 v[96:99], v[220:223], v[180:183], v[96:99]
    v_mfma_f32_16x16x32_bf16 v[132:135], v[224:227], v[180:183], v[132:135]
    v_mfma_f32_16x16x32_bf16 v[152:155], v[228:231], v[180:183], v[152:155]
    v_mfma_f32_16x16x32_bf16 v[64:67], v[216:219], v[184:187], v[64:67]
    ds_read_b128 v[176:179], v28 offset:16384
    v_mfma_f32_16x16x32_bf16 v[100:103], v[220:223], v[184:187], v[100:103]
    v_mfma_f32_16x16x32_bf16 v[136:139], v[224:227], v[184:187], v[136:139]
    v_mfma_f32_16x16x32_bf16 v[156:159], v[228:231], v[184:187], v[156:159]
    v_mfma_f32_16x16x32_bf16 v[68:71], v[216:219], v[188:191], v[68:71]
    ds_read_b128 v[180:183], v28 offset:17408
    v_mfma_f32_16x16x32_bf16 v[104:107], v[220:223], v[188:191], v[104:107]
    v_mfma_f32_16x16x32_bf16 v[140:143], v[224:227], v[188:191], v[140:143]
    v_mfma_f32_16x16x32_bf16 v[160:163], v[228:231], v[188:191], v[160:163]
    s_waitcnt lgkmcnt(4)
    v_mfma_f32_16x16x32_bf16 v[72:75], v[216:219], v[192:195], v[72:75]
    v_mfma_f32_16x16x32_bf16 v[108:111], v[220:223], v[192:195], v[108:111]
    v_mfma_f32_16x16x32_bf16 v[144:147], v[224:227], v[192:195], v[144:147]
    v_mfma_f32_16x16x32_bf16 v[164:167], v[228:231], v[192:195], v[164:167]
    s_waitcnt lgkmcnt(3)
    v_mfma_f32_16x16x32_bf16 v[76:79], v[216:219], v[168:171], v[76:79]
    v_mfma_f32_16x16x32_bf16 v[112:115], v[220:223], v[168:171], v[112:115]
    s_waitcnt lgkmcnt(2)
    v_mfma_f32_16x16x32_bf16 v[80:83], v[216:219], v[172:175], v[80:83]
    v_mfma_f32_16x16x32_bf16 v[116:119], v[220:223], v[172:175], v[116:119]
    s_waitcnt lgkmcnt(1)
    v_mfma_f32_16x16x32_bf16 v[84:87], v[216:219], v[176:179], v[84:87]
    v_mfma_f32_16x16x32_bf16 v[120:123], v[220:223], v[176:179], v[120:123]
    s_waitcnt lgkmcnt(0)
    v_mfma_f32_16x16x32_bf16 v[88:91], v[216:219], v[180:183], v[88:91]
    v_mfma_f32_16x16x32_bf16 v[124:127], v[220:223], v[180:183], v[124:127]
    s_and_b32 s40, s50, 7
    s_cmp_eq_u32 s40, 0
    s_cbranch_scc1 R_yfin3
K_yfin3:
    v_add_u32 v26, s54, v26
    v_add_u32 v27, s54, v27
    v_add_u32 v30, s55, v30
    v_add_u32 v28, s55, v28
    v_add_u32 v32, s56, v32
    v_add_u32 v33, s56, v33
    s_sub_u32 s54, 0, s54
    s_sub_u32 s55, 0, s55
    s_sub_u32 s56, 0, s56
    s_cmp_ge_u32 s50, 8
    s_cbranch_scc1 R_ost
K_ost:
    s_add_u32 s50, s50, 1
    s_cmp_lt_u32 s50, 17
    s_waitcnt lgkmcnt(0)
    s_cbranch_scc1 k1_hloop
k1_attend:
    s_waitcnt lgkmcnt(0)
    s_cmp_lt_u32 s52, 240
    s_cbranch_scc1 op_go
    s_waitcnt vmcnt(0)
    s_barrier
    s_cmp_lg_u32 s32, 0
    s_cbranch_scc1 op_end
    v_mov_b32 v3, 0
    v_mov_b32 v4, 1
    s_mov_b64 exec, 1
    buffer_atomic_add v4, v3, s[24:27], s51 offen sc1
    s_mov_b64 exec, -1
    s_branch op_end
op_go:
    s_mov_b32 s12, s84
    s_and_b32 s13, s85, 0xffff
    s_mov_b32 s14, 0x2d0000
    s_mov_b32 s15, 0x20000
    s_add_u32 s64, s88, 33554432
    s_addc_u32 s65, s89, 0
    s_mov_b32 s8, s64
    s_and_b32 s9, s65, 0xffff
    s_mov_b32 s10, 0xb40000
    s_mov_b32 s11, 0x20000
    s_lshr_b32 s40, s52, 3
    s_mul_i32 s41, s40, 39
    v_add_u32 v34, s41, v0
    v_min_u32 v34, 1151, v34
    v_lshlrev_b32 v34, 7, v34
    v_cmp_gt_u32 vcc, 39, v0
    v_mov_b32 v2, 0x7fffffff
    s_nop 0
    v_cndmask_b32 v34, v2, v34, vcc
    s_mul_i32 s41, s40, 22
    v_add_u32 v33, s41, v0
    v_min_u32 v33, 639, v33
    v_lshlrev_b32 v33, 7, v33
    v_cmp_gt_u32 vcc, 22, v0
    s_nop 1
    v_cndmask_b32 v33, v2, v33, vcc
    s_lshl_b32 s40, s66, 1
    s_add_u32 s40, s40, s28
    s_mul_i32 s40, s40, 72
    s_mul_i32 s41, s30, 12
    s_add_u32 s40, s40, s41
    s_mul_i32 s41, s49, 6
    s_add_u32 s40, s40, s41
    s_mul_i32 s40, s40, 20
    s_lshl_b32 s41, s31, 2
    s_add_u32 s40, s40, s41
    s_lshl_b32 s41, s68, 1
    s_add_u32 s40, s40, s41
    s_lshl_b32 s43, s40, 10
    s_mov_b32 s39, 0
    s_cmp_ge_u32 s32, 4
    s_cbranch_scc1 op_loopY
op_loopX:
    s_cmp_eq_u32 s39, 0
    s_cbranch_scc1 R_wX0
    s_waitcnt vmcnt(10)
K_wX0:
    s_barrier
    s_cmp_eq_u32 s39, 0
    s_cbranch_scc1 R_fX
    v_mfma_f32_16x16x32_bf16 v[56:59], v[192:195], v[208:211], v[56:59]
    ds_read_b64_tr_b16 v[152:153], v36 offset:0
    v_mfma_f32_16x16x32_bf16 v[60:63], v[196:199], v[208:211], v[60:63]
    ds_read_b64_tr_b16 v[154:155], v36 offset:1024
    v_mfma_f32_16x16x32_bf16 v[64:67], v[200:203], v[208:211], v[64:67]
    ds_read_b64_tr_b16 v[156:157], v37 offset:0
    v_mfma_f32_16x16x32_bf16 v[68:71], v[204:207], v[208:211], v[68:71]
    ds_read_b64_tr_b16 v[158:159], v37 offset:1024
    v_mfma_f32_16x16x32_bf16 v[72:75], v[192:195], v[212:215], v[72:75]
    v_mfma_f32_16x16x32_bf16 v[76:79], v[196:199], v[212:215], v[76:79]
    ds_read_b64_tr_b16 v[160:161], v38 offset:0
    v_mfma_f32_16x16x32_bf16 v[80:83], v[200:203], v[212:215], v[80:83]
    ds_read_b64_tr_b16 v[162:163], v38 offset:1024
    v_mfma_f32_16x16x32_bf16 v[84:87], v[204:207], v[212:215], v[84:87]
    ds_read_b64_tr_b16 v[164:165], v39 offset:0
    v_mfma_f32_16x16x32_bf16 v[88:91], v[192:195], v[216:219], v[88:91]
    v_mfma_f32_16x16x32_bf16 v[92:95], v[196:199], v[216:219], v[92:95]
    ds_read_b64_tr_b16 v[166:167], v39 offset:1024
    v_mfma_f32_16x16x32_bf16 v[96:99], v[200:203], v[216:219], v[96:99]
    ds_read_b128 v[168:171], v44 offset:0
    v_mfma_f32_16x16x32_bf16 v[100:103], v[204:207], v[216:219], v[100:103]
    ds_read_b128 v[172:175], v44 offset:2048
    v_mfma_f32_16x16x32_bf16 v[104:107], v[192:195], v[220:223], v[104:107]
    ds_read_b128 v[176:179], v44 offset:4096
    v_mfma_f32_16x16x32_bf16 v[108:111], v[196:199], v[220:223], v[108:111]
    v_mfma_f32_16x16x32_bf16 v[112:115], v[200:203], v[220:223], v[112:115]
    ds_read_b128 v[180:183], v44 offset:6144
    v_mfma_f32_16x16x32_bf16 v[116:119], v[204:207], v[220:223], v[116:119]
    ds_read_b128 v[184:187], v44 offset:8192
    v_mfma_f32_16x16x32_bf16 v[120:123], v[192:195], v[224:227], v[120:123]
    ds_read_b128 v[188:191], v44 offset:10240
    v_mfma_f32_16x16x32_bf16 v[124:127], v[196:199], v[224:227], v[124:127]
    v_mfma_f32_16x16x32_bf16 v[128:131], v[200:203], v[224:227], v[128:131]
    v_mfma_f32_16x16x32_bf16 v[132:135], v[204:207], v[224:227], v[132:135]
    v_mfma_f32_16x16x32_bf16 v[136:139], v[192:195], v[228:231], v[136:139]
    v_mfma_f32_16x16x32_bf16 v[140:143], v[196:199], v[228:231], v[140:143]
    v_mfma_f32_16x16x32_bf16 v[144:147], v[200:203], v[228:231], v[144:147]
    v_mfma_f32_16x16x32_bf16 v[148:151], v[204:207], v[228:231], v[148:151]
K_fX:
    s_add_u32 m0, s37, 122880
    s_add_u32 s44, s44, 1
    buffer_load_dwordx4 v9, s[80:83], s34 offen lds
    buffer_load_dwordx4 v9, s[80:83], s35 offen offset:1024 lds
    s_add_u32 m0, s38, 122880
    s_cmp_eq_u32 s44, 12
    buffer_load_dwordx4 v10, s[24:27], s36 offen lds
    buffer_load_dwordx4 v10, s[24:27], s36 offen offset:1024 lds
    buffer_load_dwordx4 v10, s[24:27], s36 offen offset:2048 lds
    s_cselect_b32 s40, 0x2e4000, s45
    s_cselect_b32 s41, 0x534000, s46
    s_add_u32 s34, s34, s40
    s_add_u32 s35, s35, s40
    s_add_u32 s36, s36, s41
    s_waitcnt lgkmcnt(0)
    s_cmp_eq_u32 s39, 2
    s_cbranch_scc1 R_p1
K_p1:
    s_cmp_eq_u32 s39, 0
    s_cbranch_scc1 R_wX1
    s_waitcnt vmcnt(10)
K_wX1:
    s_barrier
    v_mfma_f32_16x16x32_bf16 v[56:59], v[152:155], v[168:171], v[56:59]
    ds_read_b64_tr_b16 v[192:193], v36 offset:40960
    v_mfma_f32_16x16x32_bf16 v[60:63], v[156:159], v[168:171], v[60:63]
    ds_read_b64_tr_b16 v[194:195], v36 offset:41984
    v_mfma_f32_16x16x32_bf16 v[64:67], v[160:163], v[168:171], v[64:67]
    ds_read_b64_tr_b16 v[196:197], v37 offset:40960
    v_mfma_f32_16x16x32_bf16 v[68:71], v[164:167], v[168:171], v[68:71]
    ds_read_b64_tr_b16 v[198:199], v37 offset:41984
    v_mfma_f32_16x16x32_bf16 v[72:75], v[152:155], v[172:175], v[72:75]
    v_mfma_f32_16x16x32_bf16 v[76:79], v[156:159], v[172:175], v[76:79]
    ds_read_b64_tr_b16 v[200:201], v38 offset:40960
    v_mfma_f32_16x16x32_bf16 v[80:83], v[160:163], v[172:175], v[80:83]
    ds_read_b64_tr_b16 v[202:203], v38 offset:41984
    v_mfma_f32_16x16x32_bf16 v[84:87], v[164:167], v[172:175], v[84:87]
    ds_read_b64_tr_b16 v[204:205], v39 offset:40960
    v_mfma_f32_16x16x32_bf16 v[88:91], v[152:155], v[176:179], v[88:91]
    v_mfma_f32_16x16x32_bf16 v[92:95], v[156:159], v[176:179], v[92:95]
    ds_read_b64_tr_b16 v[206:207], v39 offset:41984
    v_mfma_f32_16x16x32_bf16 v[96:99], v[160:163], v[176:179], v[96:99]
    ds_read_b128 v[208:211], v44 offset:40960
    v_mfma_f32_16x16x32_bf16 v[100:103], v[164:167], v[176:179], v[100:103]
    ds_read_b128 v[212:215], v44 offset:43008
    v_mfma_f32_16x16x32_bf16 v[104:107], v[152:155], v[180:183], v[104:107]
    ds_read_b128 v[216:219], v44 offset:45056
    v_mfma_f32_16x16x32_bf16 v[108:111], v[156:159], v[180:183], v[108:111]
    v_mfma_f32_16x16x32_bf16 v[112:115], v[160:163], v[180:183], v[112:115]
    ds_read_b128 v[220:223], v44 offset:47104
    v_mfma_f32_16x16x32_bf16 v[116:119], v[164:167], v[180:183], v[116:119]
    ds_read_b128 v[224:227], v44 offset:49152
    v_mfma_f32_16x16x32_bf16 v[120:123], v[152:155], v[184:187], v[120:123]
    ds_read_b128 v[228:231], v44 offset:51200
    v_mfma_f32_16x16x32_bf16 v[124:127], v[156:159], v[184:187], v[124:127]
    v_mfma_f32_16x16x32_bf16 v[128:131], v[160:163], v[184:187], v[128:131]
    v_mfma_f32_16x16x32_bf16 v[132:135], v[164:167], v[184:187], v[132:135]
    v_mfma_f32_16x16x32_bf16 v[136:139], v[152:155], v[188:191], v[136:139]
    v_mfma_f32_16x16x32_bf16 v[140:143], v[156:159], v[188:191], v[140:143]
    v_mfma_f32_16x16x32_bf16 v[144:147], v[160:163], v[188:191], v[144:147]
    v_mfma_f32_16x16x32_bf16 v[148:151], v[164:167], v[188:191], v[148:151]
    s_cmp_ge_u32 s44, 24
    s_cbranch_scc1 KS_d_1074
    s_add_u32 m0, s37, 0
    s_add_u32 s44, s44, 1
    buffer_load_dwordx4 v9, s[80:83], s34 offen lds
    buffer_load_dwordx4 v9, s[80:83], s35 offen offset:1024 lds
    s_add_u32 m0, s38, 0
    s_cmp_eq_u32 s44, 12
    buffer_load_dwordx4 v10, s[24:27], s36 offen lds
    buffer_load_dwordx4 v10, s[24:27], s36 offen offset:1024 lds
    buffer_load_dwordx4 v10, s[24:27], s36 offen offset:2048 lds
    s_cselect_b32 s40, 0x2e4000, s45
    s_cselect_b32 s41, 0x534000, s46
    s_add_u32 s34, s34, s40
    s_add_u32 s35, s35, s40
    s_add_u32 s36, s36, s41
KS_d_1074:
    s_waitcnt lgkmcnt(0)
    s_cmp_lg_u32 s39, 5
    s_cbranch_scc1 KS_w_1075
    s_waitcnt vmcnt(5)
KS_w_1075:
    s_waitcnt vmcnt(10)
    s_barrier
    v_mfma_f32_16x16x32_bf16 v[56:59], v[192:195], v[208:211], v[56:59]
    ds_read_b64_tr_b16 v[152:153], v40 offset:0
    v_mfma_f32_16x16x32_bf16 v[60:63], v[196:199], v[208:211], v[60:63]
    ds_read_b64_tr_b16 v[154:155], v40 offset:1024
    v_mfma_f32_16x16x32_bf16 v[64:67], v[200:203], v[208:211], v[64:67]
    ds_read_b64_tr_b16 v[156:157], v41 offset:0
    v_mfma_f32_16x16x32_bf16 v[68:71], v[204:207], v[208:211], v[68:71]
    ds_read_b64_tr_b16 v[158:159], v41 offset:1024
    v_mfma_f32_16x16x32_bf16 v[72:75], v[192:195], v[212:215], v[72:75]
    v_mfma_f32_16x16x32_bf16 v[76:79], v[196:199], v[212:215], v[76:79]
    ds_read_b64_tr_b16 v[160:161], v42 offset:0
    v_mfma_f32_16x16x32_bf16 v[80:83], v[200:203], v[212:215], v[80:83]
    ds_read_b64_tr_b16 v[162:163], v42 offset:1024
    v_mfma_f32_16x16x32_bf16 v[84:87], v[204:207], v[212:215], v[84:87]
    ds_read_b64_tr_b16 v[164:165], v43 offset:0
    v_mfma_f32_16x16x32_bf16 v[88:91], v[192:195], v[216:219], v[88:91]
    v_mfma_f32_16x16x32_bf16 v[92:95], v[196:199], v[216:219], v[92:95]
    ds_read_b64_tr_b16 v[166:167], v43 offset:1024
    v_mfma_f32_16x16x32_bf16 v[96:99], v[200:203], v[216:219], v[96:99]
    ds_read_b128 v[168:171], v45 offset:0
    v_mfma_f32_16x16x32_bf16 v[100:103], v[204:207], v[216:219], v[100:103]
    ds_read_b128 v[172:175], v45 offset:2048
    v_mfma_f32_16x16x32_bf16 v[104:107], v[192:195], v[220:223], v[104:107]
    ds_read_b128 v[176:179], v45 offset:4096
    v_mfma_f32_16x16x32_bf16 v[108:111], v[196:199], v[220:223], v[108:111]
    v_mfma_f32_16x16x32_bf16 v[112:115], v[200:203], v[220:223], v[112:115]
    ds_read_b128 v[180:183], v45 offset:6144
    v_mfma_f32_16x16x32_bf16 v[116:119], v[204:207], v[220:223], v[116:119]
    ds_read_b128 v[184:187], v45 offset:8192
    v_mfma_f32_16x16x32_bf16 v[120:123], v[192:195], v[224:227], v[120:123]
    ds_read_b128 v[188:191], v45 offset:10240
    v_mfma_f32_16x16x32_bf16 v[124:127], v[196:199], v[224:227], v[124:127]
    v_mfma_f32_16x16x32_bf16 v[128:131], v[200:203], v[224:227], v[128:131]
    v_mfma_f32_16x16x32_bf16 v[132:135], v[204:207], v[224:227], v[132:135]
    v_mfma_f32_16x16x32_bf16 v[136:139], v[192:195], v[228:231], v[136:139]
    v_mfma_f32_16x16x32_bf16 v[140:143], v[196:199], v[228:231], v[140:143]
    v_mfma_f32_16x16x32_bf16 v[144:147], v[200:203], v[228:231], v[144:147]
    v_mfma_f32_16x16x32_bf16 v[148:151], v[204:207], v[228:231], v[148:151]
    s_cmp_ge_u32 s44, 24
    s_cbranch_scc1 KS_d_1076
    s_add_u32 m0, s37, 40960
    s_add_u32 s44, s44, 1
    buffer_load_dwordx4 v9, s[80:83], s34 offen lds
    buffer_load_dwordx4 v9, s[80:83], s35 offen offset:1024 lds
    s_add_u32 m0, s38, 40960
    s_cmp_eq_u32 s44, 12
    buffer_load_dwordx4 v10, s[24:27], s36 offen lds
    buffer_load_dwordx4 v10, s[24:27], s36 offen offset:1024 lds
    buffer_load_dwordx4 v10, s[24:27], s36 offen offset:2048 lds
    s_cselect_b32 s40, 0x2e4000, s45
    s_cselect_b32 s41, 0x534000, s46
    s_add_u32 s34, s34, s40
    s_add_u32 s35, s35, s40
    s_add_u32 s36, s36, s41
KS_d_1076:
    s_waitcnt lgkmcnt(0)
    s_cmp_eq_u32 s39, 0
    s_cbranch_scc1 R_s2
K_s2:
    s_cmp_lg_u32 s39, 5
    s_cbranch_scc1 KS_w_1077
    s_waitcnt vmcnt(0)
KS_w_1077:
    s_waitcnt vmcnt(10)
    s_barrier
    v_mfma_f32_16x16x32_bf16 v[56:59], v[152:155], v[168:171], v[56:59]
    ds_read_b64_tr_b16 v[192:193], v40 offset:40960
    v_mfma_f32_16x16x32_bf16 v[60:63], v[156:159], v[168:171], v[60:63]
    ds_read_b64_tr_b16 v[194:195], v40 offset:41984
    v_mfma_f32_16x16x32_bf16 v[64:67], v[160:163], v[168:171], v[64:67]
    ds_read_b64_tr_b16 v[196:197], v41 offset:40960
    v_mfma_f32_16x16x32_bf16 v[68:71], v[164:167], v[168:171], v[68:71]
    ds_read_b64_tr_b16 v[198:199], v41 offset:41984
    v_mfma_f32_16x16x32_bf16 v[72:75], v[152:155], v[172:175], v[72:75]
    v_mfma_f32_16x16x32_bf16 v[76:79], v[156:159], v[172:175], v[76:79]
    ds_read_b64_tr_b16 v[200:201], v42 offset:40960
    v_mfma_f32_16x16x32_bf16 v[80:83], v[160:163], v[172:175], v[80:83]
    ds_read_b64_tr_b16 v[202:203], v42 offset:41984
    v_mfma_f32_16x16x32_bf16 v[84:87], v[164:167], v[172:175], v[84:87]
    ds_read_b64_tr_b16 v[204:205], v43 offset:40960
    v_mfma_f32_16x16x32_bf16 v[88:91], v[152:155], v[176:179], v[88:91]
    v_mfma_f32_16x16x32_bf16 v[92:95], v[156:159], v[176:179], v[92:95]
    ds_read_b64_tr_b16 v[206:207], v43 offset:41984
    v_mfma_f32_16x16x32_bf16 v[96:99], v[160:163], v[176:179], v[96:99]
    ds_read_b128 v[208:211], v45 offset:40960
    v_mfma_f32_16x16x32_bf16 v[100:103], v[164:167], v[176:179], v[100:103]
    ds_read_b128 v[212:215], v45 offset:43008
    v_mfma_f32_16x16x32_bf16 v[104:107], v[152:155], v[180:183], v[104:107]
    ds_read_b128 v[216:219], v45 offset:45056
    v_mfma_f32_16x16x32_bf16 v[108:111], v[156:159], v[180:183], v[108:111]
    v_mfma_f32_16x16x32_bf16 v[112:115], v[160:163], v[180:183], v[112:115]
    ds_read_b128 v[220:223], v45 offset:47104
    v_mfma_f32_16x16x32_bf16 v[116:119], v[164:167], v[180:183], v[116:119]
    ds_read_b128 v[224:227], v45 offset:49152
    v_mfma_f32_16x16x32_bf16 v[120:123], v[152:155], v[184:187], v[120:123]
    ds_read_b128 v[228:231], v45 offset:51200
    v_mfma_f32_16x16x32_bf16 v[124:127], v[156:159], v[184:187], v[124:127]
    v_mfma_f32_16x16x32_bf16 v[128:131], v[160:163], v[184:187], v[128:131]
    v_mfma_f32_16x16x32_bf16 v[132:135], v[164:167], v[184:187], v[132:135]
    v_mfma_f32_16x16x32_bf16 v[136:139], v[152:155], v[188:191], v[136:139]
    v_mfma_f32_16x16x32_bf16 v[140:143], v[156:159], v[188:191], v[140:143]
    v_mfma_f32_16x16x32_bf16 v[144:147], v[160:163], v[188:191], v[144:147]
    v_mfma_f32_16x16x32_bf16 v[148:151], v[164:167], v[188:191], v[148:151]
    s_cmp_ge_u32 s44, 24
    s_cbranch_scc1 KS_d_1078
    s_add_u32 m0, s37, 81920
    s_add_u32 s44, s44, 1
    buffer_load_dwordx4 v9, s[80:83], s34 offen lds
    buffer_load_dwordx4 v9, s[80:83], s35 offen offset:1024 lds
    s_add_u32 m0, s38, 81920
    s_cmp_eq_u32 s44, 12
    buffer_load_dwordx4 v10, s[24:27], s36 offen lds
    buffer_load_dwordx4 v10, s[24:27], s36 offen offset:1024 lds
    buffer_load_dwordx4 v10, s[24:27], s36 offen offset:2048 lds
    s_cselect_b32 s40, 0x2e4000, s45
    s_cselect_b32 s41, 0x534000, s46
    s_add_u32 s34, s34, s40
    s_add_u32 s35, s35, s40
    s_add_u32 s36, s36, s41
KS_d_1078:
    s_waitcnt lgkmcnt(0)
    s_cmp_lg_u32 s39, 0
    s_cbranch_scc1 KS_t_1079
    s_mul_i32 s42, s66, 12
    s_add_u32 s42, s42, s32
    s_add_u32 s42, s42, 48
    s_mul_i32 s40, s42, 81920
    buffer_load_dword v35, v33, s[80:83], s40 offen
    s_add_u32 s40, s40, 655360
    buffer_load_dword v35, v33, s[80:83], s40 offen
KS_t_1079:
    s_add_u32 s39, s39, 1
    s_cmp_lt_u32 s39, 6
    s_cbranch_scc1 op_loopX
    s_barrier
    s_and_b32 s40, s32, 3
    s_mul_i32 s40, s40, 24576
    v_add_u32 v1, s40, v23
    v_mfma_f32_16x16x32_bf16 v[104:107], v[192:195], v[220:223], v[104:107]
    v_mfma_f32_16x16x32_bf16 v[108:111], v[196:199], v[220:223], v[108:111]
    v_mfma_f32_16x16x32_bf16 v[112:115], v[200:203], v[220:223], v[112:115]
    v_mfma_f32_16x16x32_bf16 v[116:119], v[204:207], v[220:223], v[116:119]
    v_mfma_f32_16x16x32_bf16 v[120:123], v[192:195], v[224:227], v[120:123]
    v_mfma_f32_16x16x32_bf16 v[124:127], v[196:199], v[224:227], v[124:127]
    v_mfma_f32_16x16x32_bf16 v[128:131], v[200:203], v[224:227], v[128:131]
    v_mfma_f32_16x16x32_bf16 v[132:135], v[204:207], v[224:227], v[132:135]
    v_mfma_f32_16x16x32_bf16 v[136:139], v[192:195], v[228:231], v[136:139]
    v_mfma_f32_16x16x32_bf16 v[140:143], v[196:199], v[228:231], v[140:143]
    v_mfma_f32_16x16x32_bf16 v[144:147], v[200:203], v[228:231], v[144:147]
    v_mfma_f32_16x16x32_bf16 v[148:151], v[204:207], v[228:231], v[148:151]
    v_mfma_f32_16x16x32_bf16 v[56:59], v[192:195], v[208:211], v[56:59]
    ds_write_b128 v1, v[104:107] offset:12288
    v_mfma_f32_16x16x32_bf16 v[60:63], v[196:199], v[208:211], v[60:63]
    ds_write_b128 v1, v[108:111] offset:13312
    v_mfma_f32_16x16x32_bf16 v[64:67], v[200:203], v[208:211], v[64:67]
    ds_write_b128 v1, v[112:115] offset:14336
    v_mfma_f32_16x16x32_bf16 v[68:71], v[204:207], v[208:211], v[68:71]
    ds_write_b128 v1, v[116:119] offset:15360
    v_mfma_f32_16x16x32_bf16 v[72:75], v[192:195], v[212:215], v[72:75]
    ds_write_b128 v1, v[120:123] offset:16384
    v_mfma_f32_16x16x32_bf16 v[76:79], v[196:199], v[212:215], v[76:79]
    ds_write_b128 v1, v[124:127] offset:17408
    v_mfma_f32_16x16x32_bf16 v[80:83], v[200:203], v[212:215], v[80:83]
    ds_write_b128 v1, v[128:131] offset:18432
    v_mfma_f32_16x16x32_bf16 v[84:87], v[204:207], v[212:215], v[84:87]
    ds_write_b128 v1, v[132:135] offset:19456
    v_mfma_f32_16x16x32_bf16 v[88:91], v[192:195], v[216:219], v[88:91]
    ds_write_b128 v1, v[136:139] offset:20480
    v_mfma_f32_16x16x32_bf16 v[92:95], v[196:199], v[216:219], v[92:95]
    ds_write_b128 v1, v[140:143] offset:21504
    v_mfma_f32_16x16x32_bf16 v[96:99], v[200:203], v[216:219], v[96:99]
    ds_write_b128 v1, v[144:147] offset:22528
    v_mfma_f32_16x16x32_bf16 v[100:103], v[204:207], v[216:219], v[100:103]
    ds_write_b128 v1, v[148:151] offset:23552
    s_waitcnt lgkmcnt(0)
    s_barrier
    ds_read_b128 v[152:155], v1 offset:0
    ds_read_b128 v[156:159], v1 offset:1024
    ds_read_b128 v[160:163], v1 offset:2048
    ds_read_b128 v[164:167], v1 offset:3072
    ds_read_b128 v[168:171], v1 offset:4096
    ds_read_b128 v[172:175], v1 offset:5120
    ds_read_b128 v[176:179], v1 offset:6144
    ds_read_b128 v[180:183], v1 offset:7168
    ds_read_b128 v[184:187], v1 offset:8192
    ds_read_b128 v[188:191], v1 offset:9216
    ds_read_b128 v[192:195], v1 offset:10240
    ds_read_b128 v[196:199], v1 offset:11264
    s_waitcnt lgkmcnt(11)
    v_add_f32 v56, v56, v152
    v_add_f32 v57, v57, v153
    v_add_f32 v58, v58, v154
    v_add_f32 v59, v59, v155
    v_cvt_pk_bf16_f32 v200, v56, v57
    v_cvt_pk_bf16_f32 v201, v58, v59
    s_add_u32 s40, s43, 0
    s_waitcnt lgkmcnt(10)
    v_add_f32 v60, v60, v156
    v_add_f32 v61, v61, v157
    v_add_f32 v62, v62, v158
    v_add_f32 v63, v63, v159
    v_cvt_pk_bf16_f32 v202, v60, v61
    v_cvt_pk_bf16_f32 v203, v62, v63
    buffer_store_dwordx4 v[200:203], v23, s[8:11], s40 offen offset:0 sc1
    s_waitcnt lgkmcnt(9)
    v_add_f32 v64, v64, v160
    v_add_f32 v65, v65, v161
    v_add_f32 v66, v66, v162
    v_add_f32 v67, v67, v163
    v_cvt_pk_bf16_f32 v204, v64, v65
    v_cvt_pk_bf16_f32 v205, v66, v67
    s_waitcnt lgkmcnt(8)
    v_add_f32 v68, v68, v164
    v_add_f32 v69, v69, v165
    v_add_f32 v70, v70, v166
    v_add_f32 v71, v71, v167
    v_cvt_pk_bf16_f32 v206, v68, v69
    v_cvt_pk_bf16_f32 v207, v70, v71
    buffer_store_dwordx4 v[204:207], v23, s[8:11], s40 offen offset:1024 sc1
    s_waitcnt lgkmcnt(7)
    v_add_f32 v72, v72, v168
    v_add_f32 v73, v73, v169
    v_add_f32 v74, v74, v170
    v_add_f32 v75, v75, v171
    v_cvt_pk_bf16_f32 v208, v72, v73
    v_cvt_pk_bf16_f32 v209, v74, v75
    s_add_u32 s40, s43, 20480
    s_waitcnt lgkmcnt(6)
    v_add_f32 v76, v76, v172
    v_add_f32 v77, v77, v173
    v_add_f32 v78, v78, v174
    v_add_f32 v79, v79, v175
    v_cvt_pk_bf16_f32 v210, v76, v77
    v_cvt_pk_bf16_f32 v211, v78, v79
    buffer_store_dwordx4 v[208:211], v23, s[8:11], s40 offen offset:0 sc1
    s_waitcnt lgkmcnt(5)
    v_add_f32 v80, v80, v176
    v_add_f32 v81, v81, v177
    v_add_f32 v82, v82, v178
    v_add_f32 v83, v83, v179
    v_cvt_pk_bf16_f32 v212, v80, v81
    v_cvt_pk_bf16_f32 v213, v82, v83
    s_waitcnt lgkmcnt(4)
    v_add_f32 v84, v84, v180
    v_add_f32 v85, v85, v181
    v_add_f32 v86, v86, v182
    v_add_f32 v87, v87, v183
    v_cvt_pk_bf16_f32 v214, v84, v85
    v_cvt_pk_bf16_f32 v215, v86, v87
    buffer_store_dwordx4 v[212:215], v23, s[8:11], s40 offen offset:1024 sc1
    s_waitcnt lgkmcnt(3)
    v_add_f32 v88, v88, v184
    v_add_f32 v89, v89, v185
    v_add_f32 v90, v90, v186
    v_add_f32 v91, v91, v187
    v_cvt_pk_bf16_f32 v216, v88, v89
    v_cvt_pk_bf16_f32 v217, v90, v91
    s_add_u32 s40, s43, 40960
    s_waitcnt lgkmcnt(2)
    v_add_f32 v92, v92, v188
    v_add_f32 v93, v93, v189
    v_add_f32 v94, v94, v190
    v_add_f32 v95, v95, v191
    v_cvt_pk_bf16_f32 v218, v92, v93
    v_cvt_pk_bf16_f32 v219, v94, v95
    buffer_store_dwordx4 v[216:219], v23, s[8:11], s40 offen offset:0 sc1
    s_waitcnt lgkmcnt(1)
    v_add_f32 v96, v96, v192
    v_add_f32 v97, v97, v193
    v_add_f32 v98, v98, v194
    v_add_f32 v99, v99, v195
    v_cvt_pk_bf16_f32 v220, v96, v97
    v_cvt_pk_bf16_f32 v221, v98, v99
    s_waitcnt lgkmcnt(0)
    v_add_f32 v100, v100, v196
    v_add_f32 v101, v101, v197
    v_add_f32 v102, v102, v198
    v_add_f32 v103, v103, v199
    v_cvt_pk_bf16_f32 v222, v100, v101
    v_cvt_pk_bf16_f32 v223, v102, v103
    buffer_store_dwordx4 v[220:223], v23, s[8:11], s40 offen offset:1024 sc1
    s_branch op_red
op_loopY:
    s_cmp_eq_u32 s39, 0
    s_cbranch_scc1 R_wY0
    s_waitcnt vmcnt(10)
K_wY0:
    s_barrier
    s_cmp_eq_u32 s39, 0
    s_cbranch_scc1 R_fY
    s_add_u32 m0, s37, 122880
    s_add_u32 s44, s44, 1
    buffer_load_dwordx4 v9, s[80:83], s34 offen lds
    buffer_load_dwordx4 v9, s[80:83], s35 offen offset:1024 lds
    s_add_u32 m0, s38, 122880
    s_cmp_eq_u32 s44, 12
    buffer_load_dwordx4 v10, s[24:27], s36 offen lds
    buffer_load_dwordx4 v10, s[24:27], s36 offen offset:1024 lds
    buffer_load_dwordx4 v10, s[24:27], s36 offen offset:2048 lds
    s_cselect_b32 s40, 0x2e4000, s45
    s_cselect_b32 s41, 0x534000, s46
    s_add_u32 s34, s34, s40
    s_add_u32 s35, s35, s40
    s_add_u32 s36, s36, s41
    v_mfma_f32_16x16x32_bf16 v[56:59], v[192:195], v[208:211], v[56:59]
    ds_read_b64_tr_b16 v[152:153], v36 offset:0
    v_mfma_f32_16x16x32_bf16 v[60:63], v[196:199], v[208:211], v[60:63]
    ds_read_b64_tr_b16 v[154:155], v36 offset:1024
    v_mfma_f32_16x16x32_bf16 v[64:67], v[200:203], v[208:211], v[64:67]
    ds_read_b64_tr_b16 v[156:157], v37 offset:0
    v_mfma_f32_16x16x32_bf16 v[68:71], v[204:207], v[208:211], v[68:71]
    ds_read_b64_tr_b16 v[158:159], v37 offset:1024
    v_mfma_f32_16x16x32_bf16 v[72:75], v[192:195], v[212:215], v[72:75]
    v_mfma_f32_16x16x32_bf16 v[76:79], v[196:199], v[212:215], v[76:79]
    ds_read_b64_tr_b16 v[160:161], v38 offset:0
    v_mfma_f32_16x16x32_bf16 v[80:83], v[200:203], v[212:215], v[80:83]
    ds_read_b64_tr_b16 v[162:163], v38 offset:1024
    v_mfma_f32_16x16x32_bf16 v[84:87], v[204:207], v[212:215], v[84:87]
    ds_read_b64_tr_b16 v[164:165], v39 offset:0
    v_mfma_f32_16x16x32_bf16 v[88:91], v[192:195], v[216:219], v[88:91]
    v_mfma_f32_16x16x32_bf16 v[92:95], v[196:199], v[216:219], v[92:95]
    ds_read_b64_tr_b16 v[166:167], v39 offset:1024
    v_mfma_f32_16x16x32_bf16 v[96:99], v[200:203], v[216:219], v[96:99]
    ds_read_b128 v[168:171], v44 offset:0
    v_mfma_f32_16x16x32_bf16 v[100:103], v[204:207], v[216:219], v[100:103]
    ds_read_b128 v[172:175], v44 offset:2048
    v_mfma_f32_16x16x32_bf16 v[104:107], v[192:195], v[220:223], v[104:107]
    ds_read_b128 v[176:179], v44 offset:4096
    v_mfma_f32_16x16x32_bf16 v[108:111], v[196:199], v[220:223], v[108:111]
    v_mfma_f32_16x16x32_bf16 v[112:115], v[200:203], v[220:223], v[112:115]
    ds_read_b128 v[180:183], v44 offset:6144
    v_mfma_f32_16x16x32_bf16 v[116:119], v[204:207], v[220:223], v[116:119]
    ds_read_b128 v[184:187], v44 offset:8192
    v_mfma_f32_16x16x32_bf16 v[120:123], v[192:195], v[224:227], v[120:123]
    ds_read_b128 v[188:191], v44 offset:10240
    v_mfma_f32_16x16x32_bf16 v[124:127], v[196:199], v[224:227], v[124:127]
    v_mfma_f32_16x16x32_bf16 v[128:131], v[200:203], v[224:227], v[128:131]
    v_mfma_f32_16x16x32_bf16 v[132:135], v[204:207], v[224:227], v[132:135]
    v_mfma_f32_16x16x32_bf16 v[136:139], v[192:195], v[228:231], v[136:139]
    v_mfma_f32_16x16x32_bf16 v[140:143], v[196:199], v[228:231], v[140:143]
    v_mfma_f32_16x16x32_bf16 v[144:147], v[200:203], v[228:231], v[144:147]
    v_mfma_f32_16x16x32_bf16 v[148:151], v[204:207], v[228:231], v[148:151]
K_fY:
    s_waitcnt lgkmcnt(0)
    s_cmp_eq_u32 s39, 0
    s_cbranch_scc1 R_wY1
    s_waitcnt vmcnt(10)
K_wY1:
    s_barrier
    s_cmp_ge_u32 s44, 24
    s_cbranch_scc1 KS_d_1080
    s_add_u32 m0, s37, 0
    s_add_u32 s44, s44, 1
    buffer_load_dwordx4 v9, s[80:83], s34 offen lds
    buffer_load_dwordx4 v9, s[80:83], s35 offen offset:1024 lds
    s_add_u32 m0, s38, 0
    s_cmp_eq_u32 s44, 12
    buffer_load_dwordx4 v10, s[24:27], s36 offen lds
    buffer_load_dwordx4 v10, s[24:27], s36 offen offset:1024 lds
    buffer_load_dwordx4 v10, s[24:27], s36 offen offset:2048 lds
    s_cselect_b32 s40, 0x2e4000, s45
    s_cselect_b32 s41, 0x534000, s46
    s_add_u32 s34, s34, s40
    s_add_u32 s35, s35, s40
    s_add_u32 s36, s36, s41
KS_d_1080:
    v_mfma_f32_16x16x32_bf16 v[56:59], v[152:155], v[168:171], v[56:59]
    ds_read_b64_tr_b16 v[192:193], v36 offset:40960
    v_mfma_f32_16x16x32_bf16 v[60:63], v[156:159], v[168:171], v[60:63]
    ds_read_b64_tr_b16 v[194:195], v36 offset:41984
    v_mfma_f32_16x16x32_bf16 v[64:67], v[160:163], v[168:171], v[64:67]
    ds_read_b64_tr_b16 v[196:197], v37 offset:40960
    v_mfma_f32_16x16x32_bf16 v[68:71], v[164:167], v[168:171], v[68:71]
    ds_read_b64_tr_b16 v[198:199], v37 offset:41984
    v_mfma_f32_16x16x32_bf16 v[72:75], v[152:155], v[172:175], v[72:75]
    v_mfma_f32_16x16x32_bf16 v[76:79], v[156:159], v[172:175], v[76:79]
    ds_read_b64_tr_b16 v[200:201], v38 offset:40960
    v_mfma_f32_16x16x32_bf16 v[80:83], v[160:163], v[172:175], v[80:83]
    ds_read_b64_tr_b16 v[202:203], v38 offset:41984
    v_mfma_f32_16x16x32_bf16 v[84:87], v[164:167], v[172:175], v[84:87]
    ds_read_b64_tr_b16 v[204:205], v39 offset:40960
    v_mfma_f32_16x16x32_bf16 v[88:91], v[152:155], v[176:179], v[88:91]
    v_mfma_f32_16x16x32_bf16 v[92:95], v[156:159], v[176:179], v[92:95]
    ds_read_b64_tr_b16 v[206:207], v39 offset:41984
    v_mfma_f32_16x16x32_bf16 v[96:99], v[160:163], v[176:179], v[96:99]
    ds_read_b128 v[208:211], v44 offset:40960
    v_mfma_f32_16x16x32_bf16 v[100:103], v[164:167], v[176:179], v[100:103]
    ds_read_b128 v[212:215], v44 offset:43008
    v_mfma_f32_16x16x32_bf16 v[104:107], v[152:155], v[180:183], v[104:107]
    ds_read_b128 v[216:219], v44 offset:45056
    v_mfma_f32_16x16x32_bf16 v[108:111], v[156:159], v[180:183], v[108:111]
    v_mfma_f32_16x16x32_bf16 v[112:115], v[160:163], v[180:183], v[112:115]
    ds_read_b128 v[220:223], v44 offset:47104
    v_mfma_f32_16x16x32_bf16 v[116:119], v[164:167], v[180:183], v[116:119]
    ds_read_b128 v[224:227], v44 offset:49152
    v_mfma_f32_16x16x32_bf16 v[120:123], v[152:155], v[184:187], v[120:123]
    ds_read_b128 v[228:231], v44 offset:51200
    v_mfma_f32_16x16x32_bf16 v[124:127], v[156:159], v[184:187], v[124:127]
    v_mfma_f32_16x16x32_bf16 v[128:131], v[160:163], v[184:187], v[128:131]
    v_mfma_f32_16x16x32_bf16 v[132:135], v[164:167], v[184:187], v[132:135]
    v_mfma_f32_16x16x32_bf16 v[136:139], v[152:155], v[188:191], v[136:139]
    v_mfma_f32_16x16x32_bf16 v[140:143], v[156:159], v[188:191], v[140:143]
    v_mfma_f32_16x16x32_bf16 v[144:147], v[160:163], v[188:191], v[144:147]
    v_mfma_f32_16x16x32_bf16 v[148:151], v[164:167], v[188:191], v[148:151]
    s_waitcnt lgkmcnt(0)
    s_cmp_lg_u32 s39, 5
    s_cbranch_scc1 KS_w_1081
    s_waitcnt vmcnt(5)
KS_w_1081:
    s_waitcnt vmcnt(10)
    s_barrier
    s_cmp_ge_u32 s44, 24
    s_cbranch_scc1 KS_d_1082
    s_add_u32 m0, s37, 40960
    s_add_u32 s44, s44, 1
    buffer_load_dwordx4 v9, s[80:83], s34 offen lds
    buffer_load_dwordx4 v9, s[80:83], s35 offen offset:1024 lds
    s_add_u32 m0, s38, 40960
    s_cmp_eq_u32 s44, 12
    buffer_load_dwordx4 v10, s[24:27], s36 offen lds
    buffer_load_dwordx4 v10, s[24:27], s36 offen offset:1024 lds
    buffer_load_dwordx4 v10, s[24:27], s36 offen offset:2048 lds
    s_cselect_b32 s40, 0x2e4000, s45
    s_cselect_b32 s41, 0x534000, s46
    s_add_u32 s34, s34, s40
    s_add_u32 s35, s35, s40
    s_add_u32 s36, s36, s41
KS_d_1082:
    v_mfma_f32_16x16x32_bf16 v[56:59], v[192:195], v[208:211], v[56:59]
    ds_read_b64_tr_b16 v[152:153], v40 offset:0
    v_mfma_f32_16x16x32_bf16 v[60:63], v[196:199], v[208:211], v[60:63]
    ds_read_b64_tr_b16 v[154:155], v40 offset:1024
    v_mfma_f32_16x16x32_bf16 v[64:67], v[200:203], v[208:211], v[64:67]
    ds_read_b64_tr_b16 v[156:157], v41 offset:0
    v_mfma_f32_16x16x32_bf16 v[68:71], v[204:207], v[208:211], v[68:71]
    ds_read_b64_tr_b16 v[158:159], v41 offset:1024
    v_mfma_f32_16x16x32_bf16 v[72:75], v[192:195], v[212:215], v[72:75]
    v_mfma_f32_16x16x32_bf16 v[76:79], v[196:199], v[212:215], v[76:79]
    ds_read_b64_tr_b16 v[160:161], v42 offset:0
    v_mfma_f32_16x16x32_bf16 v[80:83], v[200:203], v[212:215], v[80:83]
    ds_read_b64_tr_b16 v[162:163], v42 offset:1024
    v_mfma_f32_16x16x32_bf16 v[84:87], v[204:207], v[212:215], v[84:87]
    ds_read_b64_tr_b16 v[164:165], v43 offset:0
    v_mfma_f32_16x16x32_bf16 v[88:91], v[192:195], v[216:219], v[88:91]
    v_mfma_f32_16x16x32_bf16 v[92:95], v[196:199], v[216:219], v[92:95]
    ds_read_b64_tr_b16 v[166:167], v43 offset:1024
    v_mfma_f32_16x16x32_bf16 v[96:99], v[200:203], v[216:219], v[96:99]
    ds_read_b128 v[168:171], v45 offset:0
    v_mfma_f32_16x16x32_bf16 v[100:103], v[204:207], v[216:219], v[100:103]
    ds_read_b128 v[172:175], v45 offset:2048
    v_mfma_f32_16x16x32_bf16 v[104:107], v[192:195], v[220:223], v[104:107]
    ds_read_b128 v[176:179], v45 offset:4096
    v_mfma_f32_16x16x32_bf16 v[108:111], v[196:199], v[220:223], v[108:111]
    v_mfma_f32_16x16x32_bf16 v[112:115], v[200:203], v[220:223], v[112:115]
    ds_read_b128 v[180:183], v45 offset:6144
    v_mfma_f32_16x16x32_bf16 v[116:119], v[204:207], v[220:223], v[116:119]
    ds_read_b128 v[184:187], v45 offset:8192
    v_mfma_f32_16x16x32_bf16 v[120:123], v[192:195], v[224:227], v[120:123]
    ds_read_b128 v[188:191], v45 offset:10240
    v_mfma_f32_16x16x32_bf16 v[124:127], v[196:199], v[224:227], v[124:127]
    v_mfma_f32_16x16x32_bf16 v[128:131], v[200:203], v[224:227], v[128:131]
    v_mfma_f32_16x16x32_bf16 v[132:135], v[204:207], v[224:227], v[132:135]
    v_mfma_f32_16x16x32_bf16 v[136:139], v[192:195], v[228:231], v[136:139]
    v_mfma_f32_16x16x32_bf16 v[140:143], v[196:199], v[228:231], v[140:143]
    v_mfma_f32_16x16x32_bf16 v[144:147], v[200:203], v[228:231], v[144:147]
    v_mfma_f32_16x16x32_bf16 v[148:151], v[204:207], v[228:231], v[148:151]
    s_waitcnt lgkmcnt(0)
    s_cmp_lg_u32 s39, 5
    s_cbranch_scc1 KS_w_1083
    s_waitcnt vmcnt(0)
KS_w_1083:
    s_waitcnt vmcnt(10)
    s_barrier
    s_cmp_ge_u32 s44, 24
    s_cbranch_scc1 KS_d_1084
    s_add_u32 m0, s37, 81920
    s_add_u32 s44, s44, 1
    buffer_load_dwordx4 v9, s[80:83], s34 offen lds
    buffer_load_dwordx4 v9, s[80:83], s35 offen offset:1024 lds
    s_add_u32 m0, s38, 81920
    s_cmp_eq_u32 s44, 12
    buffer_load_dwordx4 v10, s[24:27], s36 offen lds
    buffer_load_dwordx4 v10, s[24:27], s36 offen offset:1024 lds
    buffer_load_dwordx4 v10, s[24:27], s36 offen offset:2048 lds
    s_cselect_b32 s40, 0x2e4000, s45
    s_cselect_b32 s41, 0x534000, s46
    s_add_u32 s34, s34, s40
    s_add_u32 s35, s35, s40
    s_add_u32 s36, s36, s41
KS_d_1084:
    v_mfma_f32_16x16x32_bf16 v[56:59], v[152:155], v[168:171], v[56:59]
    ds_read_b64_tr_b16 v[192:193], v40 offset:40960
    v_mfma_f32_16x16x32_bf16 v[60:63], v[156:159], v[168:171], v[60:63]
    ds_read_b64_tr_b16 v[194:195], v40 offset:41984
    v_mfma_f32_16x16x32_bf16 v[64:67], v[160:163], v[168:171], v[64:67]
    ds_read_b64_tr_b16 v[196:197], v41 offset:40960
    v_mfma_f32_16x16x32_bf16 v[68:71], v[164:167], v[168:171], v[68:71]
    ds_read_b64_tr_b16 v[198:199], v41 offset:41984
    v_mfma_f32_16x16x32_bf16 v[72:75], v[152:155], v[172:175], v[72:75]
    v_mfma_f32_16x16x32_bf16 v[76:79], v[156:159], v[172:175], v[76:79]
    ds_read_b64_tr_b16 v[200:201], v42 offset:40960
    v_mfma_f32_16x16x32_bf16 v[80:83], v[160:163], v[172:175], v[80:83]
    ds_read_b64_tr_b16 v[202:203], v42 offset:41984
    v_mfma_f32_16x16x32_bf16 v[84:87], v[164:167], v[172:175], v[84:87]
    ds_read_b64_tr_b16 v[204:205], v43 offset:40960
    v_mfma_f32_16x16x32_bf16 v[88:91], v[152:155], v[176:179], v[88:91]
    v_mfma_f32_16x16x32_bf16 v[92:95], v[156:159], v[176:179], v[92:95]
    ds_read_b64_tr_b16 v[206:207], v43 offset:41984
    v_mfma_f32_16x16x32_bf16 v[96:99], v[160:163], v[176:179], v[96:99]
    ds_read_b128 v[208:211], v45 offset:40960
    v_mfma_f32_16x16x32_bf16 v[100:103], v[164:167], v[176:179], v[100:103]
    ds_read_b128 v[212:215], v45 offset:43008
    v_mfma_f32_16x16x32_bf16 v[104:107], v[152:155], v[180:183], v[104:107]
    ds_read_b128 v[216:219], v45 offset:45056
    v_mfma_f32_16x16x32_bf16 v[108:111], v[156:159], v[180:183], v[108:111]
    v_mfma_f32_16x16x32_bf16 v[112:115], v[160:163], v[180:183], v[112:115]
    ds_read_b128 v[220:223], v45 offset:47104
    v_mfma_f32_16x16x32_bf16 v[116:119], v[164:167], v[180:183], v[116:119]
    ds_read_b128 v[224:227], v45 offset:49152
    v_mfma_f32_16x16x32_bf16 v[120:123], v[152:155], v[184:187], v[120:123]
    ds_read_b128 v[228:231], v45 offset:51200
    v_mfma_f32_16x16x32_bf16 v[124:127], v[156:159], v[184:187], v[124:127]
    v_mfma_f32_16x16x32_bf16 v[128:131], v[160:163], v[184:187], v[128:131]
    v_mfma_f32_16x16x32_bf16 v[132:135], v[164:167], v[184:187], v[132:135]
    v_mfma_f32_16x16x32_bf16 v[136:139], v[152:155], v[188:191], v[136:139]
    v_mfma_f32_16x16x32_bf16 v[140:143], v[156:159], v[188:191], v[140:143]
    v_mfma_f32_16x16x32_bf16 v[144:147], v[160:163], v[188:191], v[144:147]
    v_mfma_f32_16x16x32_bf16 v[148:151], v[164:167], v[188:191], v[148:151]
    s_waitcnt lgkmcnt(0)
    s_cmp_lg_u32 s39, 0
    s_cbranch_scc1 KS_t_1085
    s_mul_i32 s42, s66, 12
    s_add_u32 s42, s42, s32
    s_add_u32 s42, s42, 48
    s_mul_i32 s40, s42, 81920
    buffer_load_dword v35, v33, s[80:83], s40 offen
KS_t_1085:
    s_add_u32 s39, s39, 1
    s_cmp_lt_u32 s39, 6
    s_cbranch_scc1 op_loopY
    s_barrier
    s_and_b32 s40, s32, 3
    s_mul_i32 s40, s40, 24576
    v_add_u32 v1, s40, v23
    v_mfma_f32_16x16x32_bf16 v[56:59], v[192:195], v[208:211], v[56:59]
    v_mfma_f32_16x16x32_bf16 v[60:63], v[196:199], v[208:211], v[60:63]
    v_mfma_f32_16x16x32_bf16 v[64:67], v[200:203], v[208:211], v[64:67]
    v_mfma_f32_16x16x32_bf16 v[68:71], v[204:207], v[208:211], v[68:71]
    v_mfma_f32_16x16x32_bf16 v[72:75], v[192:195], v[212:215], v[72:75]
    v_mfma_f32_16x16x32_bf16 v[76:79], v[196:199], v[212:215], v[76:79]
    v_mfma_f32_16x16x32_bf16 v[80:83], v[200:203], v[212:215], v[80:83]
    v_mfma_f32_16x16x32_bf16 v[84:87], v[204:207], v[212:215], v[84:87]
    v_mfma_f32_16x16x32_bf16 v[88:91], v[192:195], v[216:219], v[88:91]
    v_mfma_f32_16x16x32_bf16 v[92:95], v[196:199], v[216:219], v[92:95]
    v_mfma_f32_16x16x32_bf16 v[96:99], v[200:203], v[216:219], v[96:99]
    v_mfma_f32_16x16x32_bf16 v[100:103], v[204:207], v[216:219], v[100:103]
    v_mfma_f32_16x16x32_bf16 v[104:107], v[192:195], v[220:223], v[104:107]
    ds_write_b128 v1, v[56:59] offset:0
    v_mfma_f32_16x16x32_bf16 v[108:111], v[196:199], v[220:223], v[108:111]
    ds_write_b128 v1, v[60:63] offset:1024
    v_mfma_f32_16x16x32_bf16 v[112:115], v[200:203], v[220:223], v[112:115]
    ds_write_b128 v1, v[64:67] offset:2048
    v_mfma_f32_16x16x32_bf16 v[116:119], v[204:207], v[220:223], v[116:119]
    ds_write_b128 v1, v[68:71] offset:3072
    v_mfma_f32_16x16x32_bf16 v[120:123], v[192:195], v[224:227], v[120:123]
    ds_write_b128 v1, v[72:75] offset:4096
    v_mfma_f32_16x16x32_bf16 v[124:127], v[196:199], v[224:227], v[124:127]
    ds_write_b128 v1, v[76:79] offset:5120
    v_mfma_f32_16x16x32_bf16 v[128:131], v[200:203], v[224:227], v[128:131]
    ds_write_b128 v1, v[80:83] offset:6144
    v_mfma_f32_16x16x32_bf16 v[132:135], v[204:207], v[224:227], v[132:135]
    ds_write_b128 v1, v[84:87] offset:7168
    v_mfma_f32_16x16x32_bf16 v[136:139], v[192:195], v[228:231], v[136:139]
    ds_write_b128 v1, v[88:91] offset:8192
    v_mfma_f32_16x16x32_bf16 v[140:143], v[196:199], v[228:231], v[140:143]
    ds_write_b128 v1, v[92:95] offset:9216
    v_mfma_f32_16x16x32_bf16 v[144:147], v[200:203], v[228:231], v[144:147]
    ds_write_b128 v1, v[96:99] offset:10240
    v_mfma_f32_16x16x32_bf16 v[148:151], v[204:207], v[228:231], v[148:151]
    ds_write_b128 v1, v[100:103] offset:11264
    s_waitcnt lgkmcnt(0)
    s_barrier
    ds_read_b128 v[152:155], v1 offset:12288
    ds_read_b128 v[156:159], v1 offset:13312
    ds_read_b128 v[160:163], v1 offset:14336
    ds_read_b128 v[164:167], v1 offset:15360
    ds_read_b128 v[168:171], v1 offset:16384
    ds_read_b128 v[172:175], v1 offset:17408
    ds_read_b128 v[176:179], v1 offset:18432
    ds_read_b128 v[180:183], v1 offset:19456
    ds_read_b128 v[184:187], v1 offset:20480
    ds_read_b128 v[188:191], v1 offset:21504
    ds_read_b128 v[192:195], v1 offset:22528
    ds_read_b128 v[196:199], v1 offset:23552
    s_waitcnt lgkmcnt(11)
    v_add_f32 v104, v104, v152
    v_add_f32 v105, v105, v153
    v_add_f32 v106, v106, v154
    v_add_f32 v107, v107, v155
    v_cvt_pk_bf16_f32 v200, v104, v105
    v_cvt_pk_bf16_f32 v201, v106, v107
    s_add_u32 s40, s43, 61440
    s_waitcnt lgkmcnt(10)
    v_add_f32 v108, v108, v156
    v_add_f32 v109, v109, v157
    v_add_f32 v110, v110, v158
    v_add_f32 v111, v111, v159
    v_cvt_pk_bf16_f32 v202, v108, v109
    v_cvt_pk_bf16_f32 v203, v110, v111
    buffer_store_dwordx4 v[200:203], v23, s[8:11], s40 offen offset:0 sc1
    s_waitcnt lgkmcnt(9)
    v_add_f32 v112, v112, v160
    v_add_f32 v113, v113, v161
    v_add_f32 v114, v114, v162
    v_add_f32 v115, v115, v163
    v_cvt_pk_bf16_f32 v204, v112, v113
    v_cvt_pk_bf16_f32 v205, v114, v115
    s_waitcnt lgkmcnt(8)
    v_add_f32 v116, v116, v164
    v_add_f32 v117, v117, v165
    v_add_f32 v118, v118, v166
    v_add_f32 v119, v119, v167
    v_cvt_pk_bf16_f32 v206, v116, v117
    v_cvt_pk_bf16_f32 v207, v118, v119
    buffer_store_dwordx4 v[204:207], v23, s[8:11], s40 offen offset:1024 sc1
    s_waitcnt lgkmcnt(7)
    v_add_f32 v120, v120, v168
    v_add_f32 v121, v121, v169
    v_add_f32 v122, v122, v170
    v_add_f32 v123, v123, v171
    v_cvt_pk_bf16_f32 v208, v120, v121
    v_cvt_pk_bf16_f32 v209, v122, v123
    s_add_u32 s40, s43, 81920
    s_waitcnt lgkmcnt(6)
    v_add_f32 v124, v124, v172
    v_add_f32 v125, v125, v173
    v_add_f32 v126, v126, v174
    v_add_f32 v127, v127, v175
    v_cvt_pk_bf16_f32 v210, v124, v125
    v_cvt_pk_bf16_f32 v211, v126, v127
    buffer_store_dwordx4 v[208:211], v23, s[8:11], s40 offen offset:0 sc1
    s_waitcnt lgkmcnt(5)
    v_add_f32 v128, v128, v176
    v_add_f32 v129, v129, v177
    v_add_f32 v130, v130, v178
    v_add_f32 v131, v131, v179
    v_cvt_pk_bf16_f32 v212, v128, v129
    v_cvt_pk_bf16_f32 v213, v130, v131
    s_waitcnt lgkmcnt(4)
    v_add_f32 v132, v132, v180
    v_add_f32 v133, v133, v181
    v_add_f32 v134, v134, v182
    v_add_f32 v135, v135, v183
    v_cvt_pk_bf16_f32 v214, v132, v133
    v_cvt_pk_bf16_f32 v215, v134, v135
    buffer_store_dwordx4 v[212:215], v23, s[8:11], s40 offen offset:1024 sc1
    s_waitcnt lgkmcnt(3)
    v_add_f32 v136, v136, v184
    v_add_f32 v137, v137, v185
    v_add_f32 v138, v138, v186
    v_add_f32 v139, v139, v187
    v_cvt_pk_bf16_f32 v216, v136, v137
    v_cvt_pk_bf16_f32 v217, v138, v139
    s_add_u32 s40, s43, 102400
    s_waitcnt lgkmcnt(2)
    v_add_f32 v140, v140, v188
    v_add_f32 v141, v141, v189
    v_add_f32 v142, v142, v190
    v_add_f32 v143, v143, v191
    v_cvt_pk_bf16_f32 v218, v140, v141
    v_cvt_pk_bf16_f32 v219, v142, v143
    buffer_store_dwordx4 v[216:219], v23, s[8:11], s40 offen offset:0 sc1
    s_waitcnt lgkmcnt(1)
    v_add_f32 v144, v144, v192
    v_add_f32 v145, v145, v193
    v_add_f32 v146, v146, v194
    v_add_f32 v147, v147, v195
    v_cvt_pk_bf16_f32 v220, v144, v145
    v_cvt_pk_bf16_f32 v221, v146, v147
    s_waitcnt lgkmcnt(0)
    v_add_f32 v148, v148, v196
    v_add_f32 v149, v149, v197
    v_add_f32 v150, v150, v198
    v_add_f32 v151, v151, v199
    v_cvt_pk_bf16_f32 v222, v148, v149
    v_cvt_pk_bf16_f32 v223, v150, v151
    buffer_store_dwordx4 v[220:223], v23, s[8:11], s40 offen offset:1024 sc1
op_red:
    s_waitcnt vmcnt(0)
    s_barrier
    s_cmp_lg_u32 s32, 0
    s_cbranch_scc1 op_w
    s_andn2_b32 s40, s52, 3
    s_lshl_b32 s40, s40, 7
    s_lshl_b32 s41, s66, 2
    s_add_u32 s40, s40, s41
    s_add_u32 s40, s40, 28311552
    v_lshlrev_b32 v3, 7, v0
    v_mov_b32 v4, 1
    s_mov_b64 exec, 15
    buffer_store_dword v4, v3, s[24:27], s40 offen sc1
    s_mov_b64 exec, -1
    s_lshl_b32 s40, s52, 7
    s_add_u32 s40, s40, 28311552
    s_mov_b32 s42, 0x40000
    v_mov_b32 v1, 0
pl2:
    buffer_load_dwordx4 v[4:7], v1, s[24:27], s40 offen sc1
    s_waitcnt vmcnt(0)
    v_min3_u32 v4, v4, v5, v6
    v_min_u32 v4, v4, v7
    s_nop 0
    v_readfirstlane_b32 s41, v4
    s_nop 0
    s_cmp_eq_u32 s41, 1
    s_cbranch_scc1 pl2_ok
    s_sleep 1
    s_sub_u32 s42, s42, 1
    s_cmp_lg_u32 s42, 0
    s_cbranch_scc1 pl2
pl2_ok:
op_w:
    s_mul_i32 s41, s66, 3
    s_lshr_b32 s40, s32, 1
    s_add_u32 s41, s41, s40
    s_mul_i32 s42, s30, 12
    s_add_u32 s41, s41, s42
    s_lshl_b32 s40, s68, 1
    s_lshl_b32 s42, s31, 2
    s_add_u32 s40, s40, s42
    s_mul_i32 s42, s28, 72
    s_add_u32 s42, s42, s41
    s_mul_i32 s42, s42, 20
    s_add_u32 s42, s42, s40
    s_lshl_b32 s43, s42, 10
    s_mul_i32 s41, s41, 40960
    s_mul_i32 s42, s28, 1280
    s_add_u32 s41, s41, s42
    s_lshl_b32 s40, s40, 6
    s_add_u32 s36, s41, s40
    v_and_b32 v3, 15, v0
    v_mul_u32_u24 v3, 2560, v3
    v_lshrrev_b32 v4, 4, v0
    v_lshl_add_u32 v3, v4, 3, v3
    s_barrier
    s_cmp_ge_u32 s32, 6
    s_cbranch_scc1 op_end
    buffer_load_dwordx4 v[88:91], v23, s[8:11], s43 offen offset:0 sc1
    buffer_load_dwordx4 v[92:95], v23, s[8:11], s43 offen offset:1024 sc1
    s_add_u32 s43, s43, 2949120
    buffer_load_dwordx4 v[96:99], v23, s[8:11], s43 offen offset:0 sc1
    buffer_load_dwordx4 v[100:103], v23, s[8:11], s43 offen offset:1024 sc1
    s_add_u32 s43, s43, 2949120
    buffer_load_dwordx4 v[104:107], v23, s[8:11], s43 offen offset:0 sc1
    buffer_load_dwordx4 v[108:111], v23, s[8:11], s43 offen offset:1024 sc1
    s_add_u32 s43, s43, 2949120
    buffer_load_dwordx4 v[112:115], v23, s[8:11], s43 offen offset:0 sc1
    buffer_load_dwordx4 v[116:119], v23, s[8:11], s43 offen offset:1024 sc1
    s_add_u32 s43, s43, 2949120
    s_waitcnt vmcnt(6)
    v_lshlrev_b32 v56, 16, v88
    v_and_b32 v57, 0xffff0000, v88
    v_lshlrev_b32 v58, 16, v89
    v_and_b32 v59, 0xffff0000, v89
    v_lshlrev_b32 v60, 16, v90
    v_and_b32 v61, 0xffff0000, v90
    v_lshlrev_b32 v62, 16, v91
    v_and_b32 v63, 0xffff0000, v91
    v_lshlrev_b32 v64, 16, v92
    v_and_b32 v65, 0xffff0000, v92
    v_lshlrev_b32 v66, 16, v93
    v_and_b32 v67, 0xffff0000, v93
    v_lshlrev_b32 v68, 16, v94
    v_and_b32 v69, 0xffff0000, v94
    v_lshlrev_b32 v70, 16, v95
    v_and_b32 v71, 0xffff0000, v95
    s_waitcnt vmcnt(4)
    v_lshlrev_b32 v5, 16, v96
    v_and_b32 v6, 0xffff0000, v96
    v_add_f32 v56, v56, v5
    v_add_f32 v57, v57, v6
    v_lshlrev_b32 v5, 16, v97
    v_and_b32 v6, 0xffff0000, v97
    v_add_f32 v58, v58, v5
    v_add_f32 v59, v59, v6
    v_lshlrev_b32 v5, 16, v98
    v_and_b32 v6, 0xffff0000, v98
    v_add_f32 v60, v60, v5
    v_add_f32 v61, v61, v6
    v_lshlrev_b32 v5, 16, v99
    v_and_b32 v6, 0xffff0000, v99
    v_add_f32 v62, v62, v5
    v_add_f32 v63, v63, v6
    v_lshlrev_b32 v5, 16, v100
    v_and_b32 v6, 0xffff0000, v100
    v_add_f32 v64, v64, v5
    v_add_f32 v65, v65, v6
    v_lshlrev_b32 v5, 16, v101
    v_and_b32 v6, 0xffff0000, v101
    v_add_f32 v66, v66, v5
    v_add_f32 v67, v67, v6
    v_lshlrev_b32 v5, 16, v102
    v_and_b32 v6, 0xffff0000, v102
    v_add_f32 v68, v68, v5
    v_add_f32 v69, v69, v6
    v_lshlrev_b32 v5, 16, v103
    v_and_b32 v6, 0xffff0000, v103
    v_add_f32 v70, v70, v5
    v_add_f32 v71, v71, v6
    s_waitcnt vmcnt(2)
    v_lshlrev_b32 v5, 16, v104
    v_and_b32 v6, 0xffff0000, v104
    v_add_f32 v56, v56, v5
    v_add_f32 v57, v57, v6
    v_lshlrev_b32 v5, 16, v105
    v_and_b32 v6, 0xffff0000, v105
    v_add_f32 v58, v58, v5
    v_add_f32 v59, v59, v6
    v_lshlrev_b32 v5, 16, v106
    v_and_b32 v6, 0xffff0000, v106
    v_add_f32 v60, v60, v5
    v_add_f32 v61, v61, v6
    v_lshlrev_b32 v5, 16, v107
    v_and_b32 v6, 0xffff0000, v107
    v_add_f32 v62, v62, v5
    v_add_f32 v63, v63, v6
    v_lshlrev_b32 v5, 16, v108
    v_and_b32 v6, 0xffff0000, v108
    v_add_f32 v64, v64, v5
    v_add_f32 v65, v65, v6
    v_lshlrev_b32 v5, 16, v109
    v_and_b32 v6, 0xffff0000, v109
    v_add_f32 v66, v66, v5
    v_add_f32 v67, v67, v6
    v_lshlrev_b32 v5, 16, v110
    v_and_b32 v6, 0xffff0000, v110
    v_add_f32 v68, v68, v5
    v_add_f32 v69, v69, v6
    v_lshlrev_b32 v5, 16, v111
    v_and_b32 v6, 0xffff0000, v111
    v_add_f32 v70, v70, v5
    v_add_f32 v71, v71, v6
    s_waitcnt vmcnt(0)
    v_lshlrev_b32 v5, 16, v112
    v_and_b32 v6, 0xffff0000, v112
    v_add_f32 v56, v56, v5
    v_add_f32 v57, v57, v6
    v_lshlrev_b32 v5, 16, v113
    v_and_b32 v6, 0xffff0000, v113
    v_add_f32 v58, v58, v5
    v_add_f32 v59, v59, v6
    v_lshlrev_b32 v5, 16, v114
    v_and_b32 v6, 0xffff0000, v114
    v_add_f32 v60, v60, v5
    v_add_f32 v61, v61, v6
    v_lshlrev_b32 v5, 16, v115
    v_and_b32 v6, 0xffff0000, v115
    v_add_f32 v62, v62, v5
    v_add_f32 v63, v63, v6
    v_lshlrev_b32 v5, 16, v116
    v_and_b32 v6, 0xffff0000, v116
    v_add_f32 v64, v64, v5
    v_add_f32 v65, v65, v6
    v_lshlrev_b32 v5, 16, v117
    v_and_b32 v6, 0xffff0000, v117
    v_add_f32 v66, v66, v5
    v_add_f32 v67, v67, v6
    v_lshlrev_b32 v5, 16, v118
    v_and_b32 v6, 0xffff0000, v118
    v_add_f32 v68, v68, v5
    v_add_f32 v69, v69, v6
    v_lshlrev_b32 v5, 16, v119
    v_and_b32 v6, 0xffff0000, v119
    v_add_f32 v70, v70, v5
    v_add_f32 v71, v71, v6
    v_cvt_pk_bf16_f32 v72, v56, v57
    v_cvt_pk_bf16_f32 v73, v58, v59
    v_cvt_pk_bf16_f32 v74, v60, v61
    v_cvt_pk_bf16_f32 v75, v62, v63
    v_cvt_pk_bf16_f32 v76, v64, v65
    v_cvt_pk_bf16_f32 v77, v66, v67
    v_cvt_pk_bf16_f32 v78, v68, v69
    v_cvt_pk_bf16_f32 v79, v70, v71
    buffer_store_dwordx2 v[72:73], v3, s[12:15], s36 offen offset:0
    buffer_store_dwordx2 v[74:75], v3, s[12:15], s36 offen offset:32
    buffer_store_dwordx2 v[76:77], v3, s[12:15], s36 offen offset:64
    buffer_store_dwordx2 v[78:79], v3, s[12:15], s36 offen offset:96
op_end:
    s_endpgm
KS_s_1013:
    s_cmp_eq_u32 s22, 3
    s_cbranch_scc1 KS_s_1009
    s_cmp_eq_u32 s22, 6
    s_cbranch_scc1 KS_s_1010
    s_cmp_eq_u32 s22, 10
    s_cselect_b32 s42, 0, 1
    s_branch KS_s_1011
KS_s_1009:
    s_cmp_ge_u32 s33, 3
    s_cbranch_scc1 KS_t_1014
    buffer_load_dword v37, v36, s[12:15], s39 offen
    buffer_load_dword v37, v38, s[8:11], s3 offen
KS_t_1014:
    s_add_u32 s39, s39, 2359296
    s_add_u32 s3, s3, 384
    s_branch KS_s_1012
KS_s_1010:
    s_cmp_ge_u32 s33, 4
    s_cbranch_scc1 KS_t_1015
    buffer_load_dword v37, v36, s[12:15], s39 offen
    buffer_load_dword v37, v38, s[8:11], s3 offen
KS_t_1015:
    s_add_u32 s39, s39, 3145728
    s_add_u32 s3, s3, 512
    s_branch KS_s_1012
KS_s_1011:
    s_cmp_eq_u32 s33, 3
    s_cbranch_scc1 KS_s_1012
    s_add_u32 s41, s43, s42
    s_and_b32 s41, s41, 7
    s_mul_i32 s41, s41, 24576
    s_add_u32 s41, s41, s34
    s_mul_i32 s42, s42, 24576
    s_lshl_b32 s40, s33, 13
    s_add_u32 s42, s42, s40
    s_add_u32 m0, s42, 0
    s_add_u32 s40, s41, 0
    buffer_load_dwordx4 v9, s[4:7], s40 offen nt lds
    buffer_load_dwordx4 v10, s[4:7], s40 offen offset:1024 nt lds
    buffer_load_dwordx4 v11, s[4:7], s40 offen offset:2048 nt lds
    buffer_load_dwordx4 v232, s[4:7], s40 offen offset:3072 nt lds
    s_add_u32 m0, s42, 4096
    s_add_u32 s40, s41, 4096
    buffer_load_dwordx4 v233, s[4:7], s40 offen nt lds
    buffer_load_dwordx4 v234, s[4:7], s40 offen offset:1024 nt lds
    buffer_load_dwordx4 v9, s[4:7], s40 offen offset:2048 nt lds
    buffer_load_dwordx4 v10, s[4:7], s40 offen offset:3072 nt lds
    s_mov_b32 s58, 2
    s_branch KS_s_1012
KS_s_1022:
    s_cmp_eq_u32 s22, 3
    s_cbranch_scc1 KS_s_1018
    s_cmp_eq_u32 s22, 6
    s_cbranch_scc1 KS_s_1019
    s_cmp_eq_u32 s22, 10
    s_cselect_b32 s42, 0, 1
    s_branch KS_s_1020
KS_s_1018:
    s_cmp_ge_u32 s33, 3
    s_cbranch_scc1 KS_t_1023
    buffer_load_dword v37, v36, s[12:15], s39 offen
    buffer_load_dword v37, v38, s[8:11], s3 offen
KS_t_1023:
    s_add_u32 s39, s39, 2359296
    s_add_u32 s3, s3, 384
    s_branch KS_s_1021
KS_s_1019:
    s_cmp_ge_u32 s33, 4
    s_cbranch_scc1 KS_t_1024
    buffer_load_dword v37, v36, s[12:15], s39 offen
    buffer_load_dword v37, v38, s[8:11], s3 offen
KS_t_1024:
    s_add_u32 s39, s39, 3145728
    s_add_u32 s3, s3, 512
    s_branch KS_s_1021
KS_s_1020:
    s_cmp_eq_u32 s33, 3
    s_cbranch_scc1 KS_s_1021
    s_add_u32 s41, s43, s42
    s_and_b32 s41, s41, 7
    s_mul_i32 s41, s41, 24576
    s_add_u32 s41, s41, s34
    s_mul_i32 s42, s42, 24576
    s_lshl_b32 s40, s33, 13
    s_add_u32 s42, s42, s40
    s_add_u32 m0, s42, 0
    s_add_u32 s40, s41, 0
    buffer_load_dwordx4 v9, s[4:7], s40 offen nt lds
    buffer_load_dwordx4 v10, s[4:7], s40 offen offset:1024 nt lds
    buffer_load_dwordx4 v11, s[4:7], s40 offen offset:2048 nt lds
    buffer_load_dwordx4 v232, s[4:7], s40 offen offset:3072 nt lds
    s_add_u32 m0, s42, 4096
    s_add_u32 s40, s41, 4096
    buffer_load_dwordx4 v233, s[4:7], s40 offen nt lds
    buffer_load_dwordx4 v234, s[4:7], s40 offen offset:1024 nt lds
    buffer_load_dwordx4 v9, s[4:7], s40 offen offset:2048 nt lds
    buffer_load_dwordx4 v10, s[4:7], s40 offen offset:3072 nt lds
    s_mov_b32 s58, 2
    s_branch KS_s_1021
KS_s_1031:
    s_cmp_eq_u32 s22, 3
    s_cbranch_scc1 KS_s_1027
    s_cmp_eq_u32 s22, 6
    s_cbranch_scc1 KS_s_1028
    s_cmp_eq_u32 s22, 10
    s_cselect_b32 s42, 0, 1
    s_branch KS_s_1029
KS_s_1027:
    s_cmp_ge_u32 s33, 3
    s_cbranch_scc1 KS_t_1032
    buffer_load_dword v37, v36, s[12:15], s39 offen
    buffer_load_dword v37, v38, s[8:11], s3 offen
KS_t_1032:
    s_add_u32 s39, s39, 2359296
    s_add_u32 s3, s3, 384
    s_branch KS_s_1030
KS_s_1028:
    s_cmp_ge_u32 s33, 4
    s_cbranch_scc1 KS_t_1033
    buffer_load_dword v37, v36, s[12:15], s39 offen
    buffer_load_dword v37, v38, s[8:11], s3 offen
KS_t_1033:
    s_add_u32 s39, s39, 3145728
    s_add_u32 s3, s3, 512
    s_branch KS_s_1030
KS_s_1029:
    s_cmp_eq_u32 s33, 3
    s_cbranch_scc1 KS_s_1030
    s_add_u32 s41, s43, s42
    s_and_b32 s41, s41, 7
    s_mul_i32 s41, s41, 24576
    s_add_u32 s41, s41, s34
    s_mul_i32 s42, s42, 24576
    s_lshl_b32 s40, s33, 13
    s_add_u32 s42, s42, s40
    s_add_u32 m0, s42, 0
    s_add_u32 s40, s41, 0
    buffer_load_dwordx4 v9, s[4:7], s40 offen nt lds
    buffer_load_dwordx4 v10, s[4:7], s40 offen offset:1024 nt lds
    buffer_load_dwordx4 v11, s[4:7], s40 offen offset:2048 nt lds
    buffer_load_dwordx4 v232, s[4:7], s40 offen offset:3072 nt lds
    s_add_u32 m0, s42, 4096
    s_add_u32 s40, s41, 4096
    buffer_load_dwordx4 v233, s[4:7], s40 offen nt lds
    buffer_load_dwordx4 v234, s[4:7], s40 offen offset:1024 nt lds
    buffer_load_dwordx4 v9, s[4:7], s40 offen offset:2048 nt lds
    buffer_load_dwordx4 v10, s[4:7], s40 offen offset:3072 nt lds
    s_mov_b32 s58, 2
    s_branch KS_s_1030
KS_s_1040:
    s_cmp_eq_u32 s22, 3
    s_cbranch_scc1 KS_s_1036
    s_cmp_eq_u32 s22, 6
    s_cbranch_scc1 KS_s_1037
    s_cmp_eq_u32 s22, 10
    s_cselect_b32 s42, 0, 1
    s_branch KS_s_1038
KS_s_1036:
    s_cmp_ge_u32 s33, 3
    s_cbranch_scc1 KS_t_1041
    buffer_load_dword v37, v36, s[12:15], s39 offen
    buffer_load_dword v37, v38, s[8:11], s3 offen
KS_t_1041:
    s_add_u32 s39, s39, 2359296
    s_add_u32 s3, s3, 384
    s_branch KS_s_1039
KS_s_1037:
    s_cmp_ge_u32 s33, 4
    s_cbranch_scc1 KS_t_1042
    buffer_load_dword v37, v36, s[12:15], s39 offen
    buffer_load_dword v37, v38, s[8:11], s3 offen
KS_t_1042:
    s_add_u32 s39, s39, 3145728
    s_add_u32 s3, s3, 512
    s_branch KS_s_1039
KS_s_1038:
    s_cmp_eq_u32 s33, 3
    s_cbranch_scc1 KS_s_1039
    s_add_u32 s41, s43, s42
    s_and_b32 s41, s41, 7
    s_mul_i32 s41, s41, 24576
    s_add_u32 s41, s41, s34
    s_mul_i32 s42, s42, 24576
    s_lshl_b32 s40, s33, 13
    s_add_u32 s42, s42, s40
    s_add_u32 m0, s42, 0
    s_add_u32 s40, s41, 0
    buffer_load_dwordx4 v9, s[4:7], s40 offen nt lds
    buffer_load_dwordx4 v10, s[4:7], s40 offen offset:1024 nt lds
    buffer_load_dwordx4 v11, s[4:7], s40 offen offset:2048 nt lds
    buffer_load_dwordx4 v232, s[4:7], s40 offen offset:3072 nt lds
    s_add_u32 m0, s42, 4096
    s_add_u32 s40, s41, 4096
    buffer_load_dwordx4 v233, s[4:7], s40 offen nt lds
    buffer_load_dwordx4 v234, s[4:7], s40 offen offset:1024 nt lds
    buffer_load_dwordx4 v9, s[4:7], s40 offen offset:2048 nt lds
    buffer_load_dwordx4 v10, s[4:7], s40 offen offset:3072 nt lds
    s_mov_b32 s58, 2
    s_branch KS_s_1039
KS_s_1049:
    s_cmp_eq_u32 s22, 3
    s_cbranch_scc1 KS_s_1045
    s_cmp_eq_u32 s22, 6
    s_cbranch_scc1 KS_s_1046
    s_cmp_eq_u32 s22, 10
    s_cselect_b32 s42, 0, 1
    s_branch KS_s_1047
KS_s_1045:
    s_cmp_ge_u32 s33, 3
    s_cbranch_scc1 KS_t_1050
    buffer_load_dword v37, v36, s[12:15], s39 offen
    buffer_load_dword v37, v38, s[8:11], s3 offen
KS_t_1050:
    s_add_u32 s39, s39, 2359296
    s_add_u32 s3, s3, 384
    s_branch KS_s_1048
KS_s_1046:
    s_cmp_ge_u32 s33, 4
    s_cbranch_scc1 KS_t_1051
    buffer_load_dword v37, v36, s[12:15], s39 offen
    buffer_load_dword v37, v38, s[8:11], s3 offen
KS_t_1051:
    s_add_u32 s39, s39, 3145728
    s_add_u32 s3, s3, 512
    s_branch KS_s_1048
KS_s_1047:
    s_cmp_eq_u32 s33, 3
    s_cbranch_scc1 KS_s_1048
    s_add_u32 s41, s43, s42
    s_and_b32 s41, s41, 7
    s_mul_i32 s41, s41, 24576
    s_add_u32 s41, s41, s34
    s_mul_i32 s42, s42, 24576
    s_lshl_b32 s40, s33, 13
    s_add_u32 s42, s42, s40
    s_add_u32 m0, s42, 0
    s_add_u32 s40, s41, 0
    buffer_load_dwordx4 v9, s[4:7], s40 offen nt lds
    buffer_load_dwordx4 v10, s[4:7], s40 offen offset:1024 nt lds
    buffer_load_dwordx4 v11, s[4:7], s40 offen offset:2048 nt lds
    buffer_load_dwordx4 v232, s[4:7], s40 offen offset:3072 nt lds
    s_add_u32 m0, s42, 4096
    s_add_u32 s40, s41, 4096
    buffer_load_dwordx4 v233, s[4:7], s40 offen nt lds
    buffer_load_dwordx4 v234, s[4:7], s40 offen offset:1024 nt lds
    buffer_load_dwordx4 v9, s[4:7], s40 offen offset:2048 nt lds
    buffer_load_dwordx4 v10, s[4:7], s40 offen offset:3072 nt lds
    s_mov_b32 s58, 2
    s_branch KS_s_1048
KS_wo_1054:
    v_min_u32 v1, 47, v0
    v_lshlrev_b32 v1, 7, v1
    s_lshl_b32 s42, s33, 13
    s_cmp_eq_u32 s33, 3
    s_cselect_b32 s42, 0, s42
    s_sub_u32 s42, s34, s42
    s_add_u32 s41, s33, 6
    s_add_u32 s40, s43, s41
    s_and_b32 s40, s40, 7
    s_mul_i32 s40, s40, 24576
    s_add_u32 s40, s40, s42
    s_cmp_ge_u32 s41, 8
    s_cselect_b32 s41, 3145728, 0
    s_add_u32 s40, s40, s41
    buffer_load_dword v7, v1, s[16:19], s40 offen
    s_add_u32 s41, s33, 10
    s_add_u32 s40, s43, s41
    s_and_b32 s40, s40, 7
    s_mul_i32 s40, s40, 24576
    s_add_u32 s40, s40, s42
    s_cmp_ge_u32 s41, 8
    s_cselect_b32 s41, 3145728, 0
    s_add_u32 s40, s40, s41
    buffer_load_dword v7, v1, s[16:19], s40 offen
    s_branch KS_wo_1055
KS_s_1060:
    s_cmp_eq_u32 s22, 3
    s_cbranch_scc1 KS_s_1056
    s_cmp_eq_u32 s22, 6
    s_cbranch_scc1 KS_s_1057
    s_cmp_eq_u32 s22, 10
    s_cselect_b32 s42, 0, 1
    s_branch KS_s_1058
KS_s_1056:
    s_cmp_ge_u32 s33, 3
    s_cbranch_scc1 KS_t_1061
    buffer_load_dword v37, v36, s[12:15], s39 offen
    buffer_load_dword v37, v38, s[8:11], s3 offen
KS_t_1061:
    s_add_u32 s39, s39, 2359296
    s_add_u32 s3, s3, 384
    s_branch KS_s_1059
KS_s_1057:
    s_cmp_ge_u32 s33, 4
    s_cbranch_scc1 KS_t_1062
    buffer_load_dword v37, v36, s[12:15], s39 offen
    buffer_load_dword v37, v38, s[8:11], s3 offen
KS_t_1062:
    s_add_u32 s39, s39, 3145728
    s_add_u32 s3, s3, 512
    s_branch KS_s_1059
KS_s_1058:
    s_cmp_eq_u32 s33, 3
    s_cbranch_scc1 KS_s_1059
    s_add_u32 s41, s43, s42
    s_and_b32 s41, s41, 7
    s_mul_i32 s41, s41, 24576
    s_add_u32 s41, s41, s34
    s_mul_i32 s42, s42, 24576
    s_lshl_b32 s40, s33, 13
    s_add_u32 s42, s42, s40
    s_add_u32 m0, s42, 0
    s_add_u32 s40, s41, 0
    buffer_load_dwordx4 v9, s[4:7], s40 offen nt lds
    buffer_load_dwordx4 v10, s[4:7], s40 offen offset:1024 nt lds
    buffer_load_dwordx4 v11, s[4:7], s40 offen offset:2048 nt lds
    buffer_load_dwordx4 v232, s[4:7], s40 offen offset:3072 nt lds
    s_add_u32 m0, s42, 4096
    s_add_u32 s40, s41, 4096
    buffer_load_dwordx4 v233, s[4:7], s40 offen nt lds
    buffer_load_dwordx4 v234, s[4:7], s40 offen offset:1024 nt lds
    buffer_load_dwordx4 v9, s[4:7], s40 offen offset:2048 nt lds
    buffer_load_dwordx4 v10, s[4:7], s40 offen offset:3072 nt lds
    s_mov_b32 s58, 2
    s_branch KS_s_1059
KS_wo_1070:
    v_min_u32 v1, 47, v0
    v_lshlrev_b32 v1, 7, v1
    s_lshl_b32 s42, s33, 13
    s_cmp_eq_u32 s33, 3
    s_cselect_b32 s42, 0, s42
    s_sub_u32 s42, s34, s42
    s_add_u32 s41, s33, 8
    s_add_u32 s40, s43, s41
    s_and_b32 s40, s40, 7
    s_mul_i32 s40, s40, 24576
    s_add_u32 s40, s40, s42
    s_cmp_ge_u32 s41, 8
    s_cselect_b32 s41, 3145728, 0
    s_add_u32 s40, s40, s41
    buffer_load_dword v7, v1, s[4:7], s40 offen
    s_add_u32 s41, s33, 12
    s_add_u32 s40, s43, s41
    s_and_b32 s40, s40, 7
    s_mul_i32 s40, s40, 24576
    s_add_u32 s40, s40, s42
    s_cmp_ge_u32 s41, 8
    s_cselect_b32 s41, 3145728, 0
    s_add_u32 s40, s40, s41
    buffer_load_dword v7, v1, s[4:7], s40 offen
    s_branch KS_wo_1071
R_xinit:
    v_mov_b32 v36, 0
    v_mov_b32 v37, 0
    v_mov_b32 v38, 0
    v_mov_b32 v42, 0
    v_mov_b32 v43, 0
    v_mov_b32 v44, 0
    v_mov_b32 v128, 0
    v_mov_b32 v129, 0
    v_mov_b32 v130, 0
    v_mov_b32 v131, 0
    v_mov_b32 v132, 0
    v_mov_b32 v133, 0
    v_mov_b32 v134, 0
    v_mov_b32 v135, 0
    v_mov_b32 v136, 0
    v_mov_b32 v137, 0
    v_mov_b32 v138, 0
    v_mov_b32 v139, 0
    v_mov_b32 v45, 0x43800000
    v_mov_b32 v46, 0xff800000
    v_mov_b32 v47, 1.0
    s_branch K_xinit
R_sm0:
    v_max3_f32 v3, v56, v57, v58
    v_max3_f32 v3, v3, v59, v60
    v_max3_f32 v3, v3, v61, v62
    v_max_f32 v3, v3, v63
    v_mov_b32 v4, v3
    s_nop 1
    v_permlane32_swap_b32 v3, v4
    v_max_f32 v3, v3, v4
    v_mov_b32 v4, v3
    s_nop 1
    v_permlane16_swap_b32 v3, v4
    v_max_f32 v3, v3, v4
    v_sub_f32 v3, v3, v42
    v_max_f32 v3, v3, v46
    v_add_f32 v4, v3, v42
    v_sub_f32 v56, v56, v4
    v_sub_f32 v57, v57, v4
    v_sub_f32 v58, v58, v4
    v_sub_f32 v59, v59, v4
    v_sub_f32 v60, v60, v4
    v_sub_f32 v61, v61, v4
    v_sub_f32 v62, v62, v4
    v_sub_f32 v63, v63, v4
    v_sub_f32 v128, v128, v3
    v_sub_f32 v129, v129, v3
    v_sub_f32 v130, v130, v3
    v_sub_f32 v131, v131, v3
    v_mov_b32 v42, v3
    v_max_f32 v3, 0, v3
    v_exp_f32 v3, -v3
    s_nop 0
    v_max_f32 v3, v3, v47
    v_mul_f32 v36, v3, v36
    v_lshrrev_b32 v4, 4, v0
    v_min_u32 v4, 2, v4
    v_cmp_eq_u32 vcc, 0, v4
    s_nop 1
    v_cndmask_b32 v2, v2, v3, vcc
    v_max3_f32 v3, v64, v65, v66
    v_max3_f32 v3, v3, v67, v68
    v_max3_f32 v3, v3, v69, v70
    v_max_f32 v3, v3, v71
    v_mov_b32 v4, v3
    s_nop 1
    v_permlane32_swap_b32 v3, v4
    v_max_f32 v3, v3, v4
    v_mov_b32 v4, v3
    s_nop 1
    v_permlane16_swap_b32 v3, v4
    v_max_f32 v3, v3, v4
    v_sub_f32 v3, v3, v43
    v_max_f32 v3, v3, v46
    v_add_f32 v4, v3, v43
    v_sub_f32 v64, v64, v4
    v_sub_f32 v65, v65, v4
    v_sub_f32 v66, v66, v4
    v_sub_f32 v67, v67, v4
    v_sub_f32 v68, v68, v4
    v_sub_f32 v69, v69, v4
    v_sub_f32 v70, v70, v4
    v_sub_f32 v71, v71, v4
    v_sub_f32 v132, v132, v3
    v_sub_f32 v133, v133, v3
    v_sub_f32 v134, v134, v3
    v_sub_f32 v135, v135, v3
    v_mov_b32 v43, v3
    v_max_f32 v3, 0, v3
    v_exp_f32 v3, -v3
    s_nop 0
    v_max_f32 v3, v3, v47
    v_mul_f32 v37, v3, v37
    v_lshrrev_b32 v4, 4, v0
    v_min_u32 v4, 2, v4
    v_cmp_eq_u32 vcc, 1, v4
    s_nop 1
    v_cndmask_b32 v2, v2, v3, vcc
    v_max3_f32 v3, v72, v73, v74
    v_max3_f32 v3, v3, v75, v76
    v_max3_f32 v3, v3, v77, v78
    v_max_f32 v3, v3, v79
    v_mov_b32 v4, v3
    s_nop 1
    v_permlane32_swap_b32 v3, v4
    v_max_f32 v3, v3, v4
    v_mov_b32 v4, v3
    s_nop 1
    v_permlane16_swap_b32 v3, v4
    v_max_f32 v3, v3, v4
    v_sub_f32 v3, v3, v44
    v_max_f32 v3, v3, v46
    v_add_f32 v4, v3, v44
    v_sub_f32 v72, v72, v4
    v_sub_f32 v73, v73, v4
    v_sub_f32 v74, v74, v4
    v_sub_f32 v75, v75, v4
    v_sub_f32 v76, v76, v4
    v_sub_f32 v77, v77, v4
    v_sub_f32 v78, v78, v4
    v_sub_f32 v79, v79, v4
    v_sub_f32 v136, v136, v3
    v_sub_f32 v137, v137, v3
    v_sub_f32 v138, v138, v3
    v_sub_f32 v139, v139, v3
    v_mov_b32 v44, v3
    v_max_f32 v3, 0, v3
    v_exp_f32 v3, -v3
    s_nop 0
    v_max_f32 v3, v3, v47
    v_mul_f32 v38, v3, v38
    v_lshrrev_b32 v4, 4, v0
    v_min_u32 v4, 2, v4
    v_cmp_eq_u32 vcc, 2, v4
    s_nop 1
    v_cndmask_b32 v2, v2, v3, vcc
    v_mov_b32 v46, 0
    v_mov_b32 v47, 0
    v_mov_b32 v45, -1.0
    v_exp_f32 v48, v56
    v_exp_f32 v49, v57
    v_exp_f32 v50, v58
    v_exp_f32 v51, v59
    v_exp_f32 v52, v60
    v_exp_f32 v53, v61
    v_exp_f32 v54, v62
    v_exp_f32 v55, v63
    v_cvt_pk_bf16_f32 v140, v48, v49
    v_cvt_pk_bf16_f32 v141, v50, v51
    v_cvt_pk_bf16_f32 v142, v52, v53
    v_cvt_pk_bf16_f32 v143, v54, v55
    ds_write_b128 v29, v[140:143] offset:0
    v_add_f32 v48, v48, v52
    v_add_f32 v49, v49, v53
    v_add_f32 v50, v50, v54
    v_add_f32 v51, v51, v55
    v_add_f32 v48, v48, v49
    v_add_f32 v50, v50, v51
    v_add_f32 v39, v48, v50
    v_exp_f32 v148, v64
    v_exp_f32 v149, v65
    v_exp_f32 v150, v66
    v_exp_f32 v151, v67
    v_exp_f32 v152, v68
    v_exp_f32 v153, v69
    v_exp_f32 v154, v70
    v_exp_f32 v155, v71
    v_cvt_pk_bf16_f32 v144, v148, v149
    v_cvt_pk_bf16_f32 v145, v150, v151
    v_cvt_pk_bf16_f32 v146, v152, v153
    v_cvt_pk_bf16_f32 v147, v154, v155
    ds_write_b128 v29, v[144:147] offset:1024
    v_add_f32 v148, v148, v152
    v_add_f32 v149, v149, v153
    v_add_f32 v150, v150, v154
    v_add_f32 v151, v151, v155
    v_add_f32 v148, v148, v149
    v_add_f32 v150, v150, v151
    v_add_f32 v40, v148, v150
    v_exp_f32 v48, v72
    v_exp_f32 v49, v73
    v_exp_f32 v50, v74
    v_exp_f32 v51, v75
    v_exp_f32 v52, v76
    v_exp_f32 v53, v77
    v_exp_f32 v54, v78
    v_exp_f32 v55, v79
    v_cvt_pk_bf16_f32 v140, v48, v49
    v_cvt_pk_bf16_f32 v141, v50, v51
    v_cvt_pk_bf16_f32 v142, v52, v53
    v_cvt_pk_bf16_f32 v143, v54, v55
    ds_write_b128 v29, v[140:143] offset:2048
    v_add_f32 v48, v48, v52
    v_add_f32 v49, v49, v53
    v_add_f32 v50, v50, v54
    v_add_f32 v51, v51, v55
    v_add_f32 v48, v48, v49
    v_add_f32 v50, v50, v51
    v_add_f32 v41, v48, v50
    s_branch K_sm0
R_sm1:
    v_max3_f32 v3, v80, v81, v82
    v_max3_f32 v3, v3, v83, v84
    v_max3_f32 v3, v3, v85, v86
    v_max_f32 v3, v3, v87
    v_mov_b32 v4, v3
    s_nop 1
    v_permlane32_swap_b32 v3, v4
    v_max_f32 v3, v3, v4
    v_mov_b32 v4, v3
    s_nop 1
    v_permlane16_swap_b32 v3, v4
    v_max_f32 v3, v3, v4
    v_sub_f32 v3, v3, v42
    v_max_f32 v3, v3, v46
    v_add_f32 v4, v3, v42
    v_sub_f32 v80, v80, v4
    v_sub_f32 v81, v81, v4
    v_sub_f32 v82, v82, v4
    v_sub_f32 v83, v83, v4
    v_sub_f32 v84, v84, v4
    v_sub_f32 v85, v85, v4
    v_sub_f32 v86, v86, v4
    v_sub_f32 v87, v87, v4
    v_sub_f32 v128, v128, v3
    v_sub_f32 v129, v129, v3
    v_sub_f32 v130, v130, v3
    v_sub_f32 v131, v131, v3
    v_mov_b32 v42, 0
    v_max_f32 v3, 0, v3
    v_exp_f32 v3, -v3
    s_nop 0
    v_max_f32 v3, v3, v47
    v_mul_f32 v36, v3, v36
    v_lshrrev_b32 v4, 4, v0
    v_min_u32 v4, 2, v4
    v_cmp_eq_u32 vcc, 0, v4
    s_nop 1
    v_cndmask_b32 v2, v2, v3, vcc
    v_max3_f32 v3, v88, v89, v90
    v_max3_f32 v3, v3, v91, v92
    v_max3_f32 v3, v3, v93, v94
    v_max_f32 v3, v3, v95
    v_mov_b32 v4, v3
    s_nop 1
    v_permlane32_swap_b32 v3, v4
    v_max_f32 v3, v3, v4
    v_mov_b32 v4, v3
    s_nop 1
    v_permlane16_swap_b32 v3, v4
    v_max_f32 v3, v3, v4
    v_sub_f32 v3, v3, v43
    v_max_f32 v3, v3, v46
    v_add_f32 v4, v3, v43
    v_sub_f32 v88, v88, v4
    v_sub_f32 v89, v89, v4
    v_sub_f32 v90, v90, v4
    v_sub_f32 v91, v91, v4
    v_sub_f32 v92, v92, v4
    v_sub_f32 v93, v93, v4
    v_sub_f32 v94, v94, v4
    v_sub_f32 v95, v95, v4
    v_sub_f32 v132, v132, v3
    v_sub_f32 v133, v133, v3
    v_sub_f32 v134, v134, v3
    v_sub_f32 v135, v135, v3
    v_mov_b32 v43, 0
    v_max_f32 v3, 0, v3
    v_exp_f32 v3, -v3
    s_nop 0
    v_max_f32 v3, v3, v47
    v_mul_f32 v37, v3, v37
    v_lshrrev_b32 v4, 4, v0
    v_min_u32 v4, 2, v4
    v_cmp_eq_u32 vcc, 1, v4
    s_nop 1
    v_cndmask_b32 v2, v2, v3, vcc
    v_max3_f32 v3, v96, v97, v98
    v_max3_f32 v3, v3, v99, v100
    v_max3_f32 v3, v3, v101, v102
    v_max_f32 v3, v3, v103
    v_mov_b32 v4, v3
    s_nop 1
    v_permlane32_swap_b32 v3, v4
    v_max_f32 v3, v3, v4
    v_mov_b32 v4, v3
    s_nop 1
    v_permlane16_swap_b32 v3, v4
    v_max_f32 v3, v3, v4
    v_sub_f32 v3, v3, v44
    v_max_f32 v3, v3, v46
    v_add_f32 v4, v3, v44
    v_sub_f32 v96, v96, v4
    v_sub_f32 v97, v97, v4
    v_sub_f32 v98, v98, v4
    v_sub_f32 v99, v99, v4
    v_sub_f32 v100, v100, v4
    v_sub_f32 v101, v101, v4
    v_sub_f32 v102, v102, v4
    v_sub_f32 v103, v103, v4
    v_sub_f32 v136, v136, v3
    v_sub_f32 v137, v137, v3
    v_sub_f32 v138, v138, v3
    v_sub_f32 v139, v139, v3
    v_mov_b32 v44, 0
    v_max_f32 v3, 0, v3
    v_exp_f32 v3, -v3
    s_nop 0
    v_max_f32 v3, v3, v47
    v_mul_f32 v38, v3, v38
    v_lshrrev_b32 v4, 4, v0
    v_min_u32 v4, 2, v4
    v_cmp_eq_u32 vcc, 2, v4
    s_nop 1
    v_cndmask_b32 v2, v2, v3, vcc
    v_mov_b32 v46, 0
    v_mov_b32 v47, 0
    v_mov_b32 v45, 0x43800000
    v_exp_f32 v48, v80
    v_exp_f32 v49, v81
    v_exp_f32 v50, v82
    v_exp_f32 v51, v83
    v_exp_f32 v52, v84
    v_exp_f32 v53, v85
    v_exp_f32 v54, v86
    v_exp_f32 v55, v87
    v_cvt_pk_bf16_f32 v140, v48, v49
    v_cvt_pk_bf16_f32 v141, v50, v51
    v_cvt_pk_bf16_f32 v142, v52, v53
    v_cvt_pk_bf16_f32 v143, v54, v55
    ds_write_b128 v29, v[140:143] offset:9216
    v_add_f32 v48, v48, v52
    v_add_f32 v49, v49, v53
    v_add_f32 v50, v50, v54
    v_add_f32 v51, v51, v55
    v_add_f32 v48, v48, v49
    v_add_f32 v50, v50, v51
    v_add_f32 v39, v48, v50
    v_exp_f32 v148, v88
    v_exp_f32 v149, v89
    v_exp_f32 v150, v90
    v_exp_f32 v151, v91
    v_exp_f32 v152, v92
    v_exp_f32 v153, v93
    v_exp_f32 v154, v94
    v_exp_f32 v155, v95
    v_cvt_pk_bf16_f32 v144, v148, v149
    v_cvt_pk_bf16_f32 v145, v150, v151
    v_cvt_pk_bf16_f32 v146, v152, v153
    v_cvt_pk_bf16_f32 v147, v154, v155
    ds_write_b128 v29, v[144:147] offset:10240
    v_add_f32 v148, v148, v152
    v_add_f32 v149, v149, v153
    v_add_f32 v150, v150, v154
    v_add_f32 v151, v151, v155
    v_add_f32 v148, v148, v149
    v_add_f32 v150, v150, v151
    v_add_f32 v40, v148, v150
    v_exp_f32 v48, v96
    v_exp_f32 v49, v97
    v_exp_f32 v50, v98
    v_exp_f32 v51, v99
    v_exp_f32 v52, v100
    v_exp_f32 v53, v101
    v_exp_f32 v54, v102
    v_exp_f32 v55, v103
    v_cvt_pk_bf16_f32 v140, v48, v49
    v_cvt_pk_bf16_f32 v141, v50, v51
    v_cvt_pk_bf16_f32 v142, v52, v53
    v_cvt_pk_bf16_f32 v143, v54, v55
    ds_write_b128 v29, v[140:143] offset:11264
    v_add_f32 v48, v48, v52
    v_add_f32 v49, v49, v53
    v_add_f32 v50, v50, v54
    v_add_f32 v51, v51, v55
    v_add_f32 v48, v48, v49
    v_add_f32 v50, v50, v51
    v_add_f32 v41, v48, v50
    s_branch K_sm1
R_xfin:
    s_mul_i32 s40, s33, 192
    v_add_u32 v3, s40, v34
    v_mov_b32 v4, v36
    s_nop 1
    v_permlane32_swap_b32 v36, v4
    v_add_f32 v36, v36, v4
    v_mov_b32 v4, v36
    s_nop 1
    v_permlane16_swap_b32 v36, v4
    v_add_f32 v36, v36, v4
    v_rcp_f32 v36, v36
    s_nop 0
    ds_write_b32 v3, v36 offset:0
    v_mov_b32 v4, v37
    s_nop 1
    v_permlane32_swap_b32 v37, v4
    v_add_f32 v37, v37, v4
    v_mov_b32 v4, v37
    s_nop 1
    v_permlane16_swap_b32 v37, v4
    v_add_f32 v37, v37, v4
    v_rcp_f32 v37, v37
    s_nop 0
    ds_write_b32 v3, v37 offset:64
    v_mov_b32 v4, v38
    s_nop 1
    v_permlane32_swap_b32 v38, v4
    v_add_f32 v38, v38, v4
    v_mov_b32 v4, v38
    s_nop 1
    v_permlane16_swap_b32 v38, v4
    v_add_f32 v38, v38, v4
    v_rcp_f32 v38, v38
    s_nop 0
    ds_write_b32 v3, v38 offset:128
    s_branch K_xfin
R_xst:
    s_cmp_eq_u32 s50, 11
    s_cbranch_scc1 xst12
    s_lshr_b32 s40, s50, 4
    s_mul_i32 s40, s40, 7077888
    s_add_u32 s42, s40, s47
    s_lshr_b32 s41, s20, 1
    s_mul_i32 s41, s41, 147456
    s_and_b32 s40, s20, 1
    s_lshl_b32 s40, s40, 10
    s_add_u32 s40, s40, s41
    s_add_u32 s40, s40, s42
    v_add_u32 v1, s40, v35
    s_add_u32 s40, s42, 294912
    v_add_u32 v2, s40, v35
    s_cmp_eq_u32 s50, 9
    s_cbranch_scc1 xst9
    s_cmp_eq_u32 s50, 10
    s_cbranch_scc1 xst10
    s_waitcnt vmcnt(0)
    buffer_store_dwordx4 v[156:159], v1, s[24:27], s69 offen sc1
    buffer_store_dwordx4 v[160:163], v1, s[24:27], s70 offen sc1
    buffer_store_dwordx4 v[164:167], v1, s[24:27], s71 offen sc1
    s_branch K_xst
xst9:
    buffer_store_dwordx4 v[168:171], v1, s[24:27], s72 offen sc1
    buffer_store_dwordx4 v[172:175], v1, s[24:27], s73 offen sc1
    buffer_store_dwordx4 v[176:179], v1, s[24:27], s74 offen sc1
    s_branch K_xst
xst10:
    buffer_store_dwordx4 v[180:183], v1, s[24:27], s75 offen sc1
    buffer_store_dwordx4 v[12:15], v1, s[24:27], s64 offen sc1
    buffer_store_dwordx4 v[16:19], v1, s[24:27], s65 offen sc1
    s_branch K_xst
xst12:
    s_waitcnt vmcnt(0)
    s_branch K_xst
R_lz:
    v_mov_b32 v56, 0
    v_mov_b32 v57, 0
    v_mov_b32 v58, 0
    v_mov_b32 v59, 0
    v_mov_b32 v60, 0
    v_mov_b32 v61, 0
    v_mov_b32 v62, 0
    v_mov_b32 v63, 0
    v_mov_b32 v64, 0
    v_mov_b32 v65, 0
    v_mov_b32 v66, 0
    v_mov_b32 v67, 0
    v_mov_b32 v68, 0
    v_mov_b32 v69, 0
    v_mov_b32 v70, 0
    v_mov_b32 v71, 0
    v_mov_b32 v72, 0
    v_mov_b32 v73, 0
    v_mov_b32 v74, 0
    v_mov_b32 v75, 0
    v_mov_b32 v76, 0
    v_mov_b32 v77, 0
    v_mov_b32 v78, 0
    v_mov_b32 v79, 0
    v_mov_b32 v80, 0
    v_mov_b32 v81, 0
    v_mov_b32 v82, 0
    v_mov_b32 v83, 0
    v_mov_b32 v84, 0
    v_mov_b32 v85, 0
    v_mov_b32 v86, 0
    v_mov_b32 v87, 0
    v_mov_b32 v88, 0
    v_mov_b32 v89, 0
    v_mov_b32 v90, 0
    v_mov_b32 v91, 0
    v_mov_b32 v92, 0
    v_mov_b32 v93, 0
    v_mov_b32 v94, 0
    v_mov_b32 v95, 0
    v_mov_b32 v96, 0
    v_mov_b32 v97, 0
    v_mov_b32 v98, 0
    v_mov_b32 v99, 0
    v_mov_b32 v100, 0
    v_mov_b32 v101, 0
    v_mov_b32 v102, 0
    v_mov_b32 v103, 0
    v_mov_b32 v104, 0
    v_mov_b32 v105, 0
    v_mov_b32 v106, 0
    v_mov_b32 v107, 0
    v_mov_b32 v108, 0
    v_mov_b32 v109, 0
    v_mov_b32 v110, 0
    v_mov_b32 v111, 0
    v_mov_b32 v112, 0
    v_mov_b32 v113, 0
    v_mov_b32 v114, 0
    v_mov_b32 v115, 0
    v_mov_b32 v116, 0
    v_mov_b32 v117, 0
    v_mov_b32 v118, 0
    v_mov_b32 v119, 0
    v_mov_b32 v120, 0
    v_mov_b32 v121, 0
    v_mov_b32 v122, 0
    v_mov_b32 v123, 0
    v_mov_b32 v124, 0
    v_mov_b32 v125, 0
    v_mov_b32 v126, 0
    v_mov_b32 v127, 0
    s_branch k1_lk
R_rs20:
    s_nop 7
    s_add_u32 s40, s21, 0
    s_cmp_ge_u32 s40, 9
    s_cselect_b32 s41, 9, 0
    s_sub_u32 s40, s40, s41
    s_lshl_b32 s40, s40, 6
    v_add_u32 v2, s40, v33
    ds_read_b32 v3, v2 offset:0
    s_waitcnt lgkmcnt(0)
    v_mul_f32 v56, v3, v56
    v_mul_f32 v57, v3, v57
    v_mul_f32 v58, v3, v58
    v_mul_f32 v59, v3, v59
    v_mul_f32 v92, v3, v92
    v_mul_f32 v93, v3, v93
    v_mul_f32 v94, v3, v94
    v_mul_f32 v95, v3, v95
    s_add_u32 s40, s21, 1
    s_cmp_ge_u32 s40, 9
    s_cselect_b32 s41, 9, 0
    s_sub_u32 s40, s40, s41
    s_lshl_b32 s40, s40, 6
    v_add_u32 v2, s40, v33
    ds_read_b32 v3, v2 offset:0
    s_waitcnt lgkmcnt(0)
    v_mul_f32 v60, v3, v60
    v_mul_f32 v61, v3, v61
    v_mul_f32 v62, v3, v62
    v_mul_f32 v63, v3, v63
    v_mul_f32 v96, v3, v96
    v_mul_f32 v97, v3, v97
    v_mul_f32 v98, v3, v98
    v_mul_f32 v99, v3, v99
    s_add_u32 s40, s21, 2
    s_cmp_ge_u32 s40, 9
    s_cselect_b32 s41, 9, 0
    s_sub_u32 s40, s40, s41
    s_lshl_b32 s40, s40, 6
    v_add_u32 v2, s40, v33
    ds_read_b32 v3, v2 offset:0
    s_waitcnt lgkmcnt(0)
    v_mul_f32 v64, v3, v64
    v_mul_f32 v65, v3, v65
    v_mul_f32 v66, v3, v66
    v_mul_f32 v67, v3, v67
    v_mul_f32 v100, v3, v100
    v_mul_f32 v101, v3, v101
    v_mul_f32 v102, v3, v102
    v_mul_f32 v103, v3, v103
    s_add_u32 s40, s21, 3
    s_cmp_ge_u32 s40, 9
    s_cselect_b32 s41, 9, 0
    s_sub_u32 s40, s40, s41
    s_lshl_b32 s40, s40, 6
    v_add_u32 v2, s40, v33
    ds_read_b32 v3, v2 offset:0
    s_waitcnt lgkmcnt(0)
    v_mul_f32 v68, v3, v68
    v_mul_f32 v69, v3, v69
    v_mul_f32 v70, v3, v70
    v_mul_f32 v71, v3, v71
    v_mul_f32 v104, v3, v104
    v_mul_f32 v105, v3, v105
    v_mul_f32 v106, v3, v106
    v_mul_f32 v107, v3, v107
    s_add_u32 s40, s21, 4
    s_cmp_ge_u32 s40, 9
    s_cselect_b32 s41, 9, 0
    s_sub_u32 s40, s40, s41
    s_lshl_b32 s40, s40, 6
    v_add_u32 v2, s40, v33
    ds_read_b32 v3, v2 offset:0
    s_waitcnt lgkmcnt(0)
    v_mul_f32 v72, v3, v72
    v_mul_f32 v73, v3, v73
    v_mul_f32 v74, v3, v74
    v_mul_f32 v75, v3, v75
    v_mul_f32 v108, v3, v108
    v_mul_f32 v109, v3, v109
    v_mul_f32 v110, v3, v110
    v_mul_f32 v111, v3, v111
    s_add_u32 s40, s21, 5
    s_cmp_ge_u32 s40, 9
    s_cselect_b32 s41, 9, 0
    s_sub_u32 s40, s40, s41
    s_lshl_b32 s40, s40, 6
    v_add_u32 v2, s40, v33
    ds_read_b32 v3, v2 offset:0
    s_waitcnt lgkmcnt(0)
    v_mul_f32 v76, v3, v76
    v_mul_f32 v77, v3, v77
    v_mul_f32 v78, v3, v78
    v_mul_f32 v79, v3, v79
    v_mul_f32 v112, v3, v112
    v_mul_f32 v113, v3, v113
    v_mul_f32 v114, v3, v114
    v_mul_f32 v115, v3, v115
    s_add_u32 s40, s21, 6
    s_cmp_ge_u32 s40, 9
    s_cselect_b32 s41, 9, 0
    s_sub_u32 s40, s40, s41
    s_lshl_b32 s40, s40, 6
    v_add_u32 v2, s40, v33
    ds_read_b32 v3, v2 offset:0
    s_waitcnt lgkmcnt(0)
    v_mul_f32 v80, v3, v80
    v_mul_f32 v81, v3, v81
    v_mul_f32 v82, v3, v82
    v_mul_f32 v83, v3, v83
    v_mul_f32 v116, v3, v116
    v_mul_f32 v117, v3, v117
    v_mul_f32 v118, v3, v118
    v_mul_f32 v119, v3, v119
    s_add_u32 s40, s21, 7
    s_cmp_ge_u32 s40, 9
    s_cselect_b32 s41, 9, 0
    s_sub_u32 s40, s40, s41
    s_lshl_b32 s40, s40, 6
    v_add_u32 v2, s40, v33
    ds_read_b32 v3, v2 offset:0
    s_waitcnt lgkmcnt(0)
    v_mul_f32 v84, v3, v84
    v_mul_f32 v85, v3, v85
    v_mul_f32 v86, v3, v86
    v_mul_f32 v87, v3, v87
    v_mul_f32 v120, v3, v120
    v_mul_f32 v121, v3, v121
    v_mul_f32 v122, v3, v122
    v_mul_f32 v123, v3, v123
    s_add_u32 s40, s21, 8
    s_cmp_ge_u32 s40, 9
    s_cselect_b32 s41, 9, 0
    s_sub_u32 s40, s40, s41
    s_lshl_b32 s40, s40, 6
    v_add_u32 v2, s40, v33
    ds_read_b32 v3, v2 offset:0
    s_waitcnt lgkmcnt(0)
    v_mul_f32 v88, v3, v88
    v_mul_f32 v89, v3, v89
    v_mul_f32 v90, v3, v90
    v_mul_f32 v91, v3, v91
    v_mul_f32 v124, v3, v124
    v_mul_f32 v125, v3, v125
    v_mul_f32 v126, v3, v126
    v_mul_f32 v127, v3, v127
    s_nop 1
    s_branch K_rs20
R_rs21:
    s_nop 7
    s_add_u32 s40, s21, 0
    s_cmp_ge_u32 s40, 9
    s_cselect_b32 s41, 9, 0
    s_sub_u32 s40, s40, s41
    s_lshl_b32 s40, s40, 6
    v_add_u32 v2, s40, v33
    ds_read_b32 v3, v2 offset:640
    s_waitcnt lgkmcnt(0)
    v_mul_f32 v56, v3, v56
    v_mul_f32 v57, v3, v57
    v_mul_f32 v58, v3, v58
    v_mul_f32 v59, v3, v59
    v_mul_f32 v92, v3, v92
    v_mul_f32 v93, v3, v93
    v_mul_f32 v94, v3, v94
    v_mul_f32 v95, v3, v95
    s_add_u32 s40, s21, 1
    s_cmp_ge_u32 s40, 9
    s_cselect_b32 s41, 9, 0
    s_sub_u32 s40, s40, s41
    s_lshl_b32 s40, s40, 6
    v_add_u32 v2, s40, v33
    ds_read_b32 v3, v2 offset:640
    s_waitcnt lgkmcnt(0)
    v_mul_f32 v60, v3, v60
    v_mul_f32 v61, v3, v61
    v_mul_f32 v62, v3, v62
    v_mul_f32 v63, v3, v63
    v_mul_f32 v96, v3, v96
    v_mul_f32 v97, v3, v97
    v_mul_f32 v98, v3, v98
    v_mul_f32 v99, v3, v99
    s_add_u32 s40, s21, 2
    s_cmp_ge_u32 s40, 9
    s_cselect_b32 s41, 9, 0
    s_sub_u32 s40, s40, s41
    s_lshl_b32 s40, s40, 6
    v_add_u32 v2, s40, v33
    ds_read_b32 v3, v2 offset:640
    s_waitcnt lgkmcnt(0)
    v_mul_f32 v64, v3, v64
    v_mul_f32 v65, v3, v65
    v_mul_f32 v66, v3, v66
    v_mul_f32 v67, v3, v67
    v_mul_f32 v100, v3, v100
    v_mul_f32 v101, v3, v101
    v_mul_f32 v102, v3, v102
    v_mul_f32 v103, v3, v103
    s_add_u32 s40, s21, 3
    s_cmp_ge_u32 s40, 9
    s_cselect_b32 s41, 9, 0
    s_sub_u32 s40, s40, s41
    s_lshl_b32 s40, s40, 6
    v_add_u32 v2, s40, v33
    ds_read_b32 v3, v2 offset:640
    s_waitcnt lgkmcnt(0)
    v_mul_f32 v68, v3, v68
    v_mul_f32 v69, v3, v69
    v_mul_f32 v70, v3, v70
    v_mul_f32 v71, v3, v71
    v_mul_f32 v104, v3, v104
    v_mul_f32 v105, v3, v105
    v_mul_f32 v106, v3, v106
    v_mul_f32 v107, v3, v107
    s_add_u32 s40, s21, 4
    s_cmp_ge_u32 s40, 9
    s_cselect_b32 s41, 9, 0
    s_sub_u32 s40, s40, s41
    s_lshl_b32 s40, s40, 6
    v_add_u32 v2, s40, v33
    ds_read_b32 v3, v2 offset:640
    s_waitcnt lgkmcnt(0)
    v_mul_f32 v72, v3, v72
    v_mul_f32 v73, v3, v73
    v_mul_f32 v74, v3, v74
    v_mul_f32 v75, v3, v75
    v_mul_f32 v108, v3, v108
    v_mul_f32 v109, v3, v109
    v_mul_f32 v110, v3, v110
    v_mul_f32 v111, v3, v111
    s_add_u32 s40, s21, 5
    s_cmp_ge_u32 s40, 9
    s_cselect_b32 s41, 9, 0
    s_sub_u32 s40, s40, s41
    s_lshl_b32 s40, s40, 6
    v_add_u32 v2, s40, v33
    ds_read_b32 v3, v2 offset:640
    s_waitcnt lgkmcnt(0)
    v_mul_f32 v76, v3, v76
    v_mul_f32 v77, v3, v77
    v_mul_f32 v78, v3, v78
    v_mul_f32 v79, v3, v79
    v_mul_f32 v112, v3, v112
    v_mul_f32 v113, v3, v113
    v_mul_f32 v114, v3, v114
    v_mul_f32 v115, v3, v115
    s_add_u32 s40, s21, 6
    s_cmp_ge_u32 s40, 9
    s_cselect_b32 s41, 9, 0
    s_sub_u32 s40, s40, s41
    s_lshl_b32 s40, s40, 6
    v_add_u32 v2, s40, v33
    ds_read_b32 v3, v2 offset:640
    s_waitcnt lgkmcnt(0)
    v_mul_f32 v80, v3, v80
    v_mul_f32 v81, v3, v81
    v_mul_f32 v82, v3, v82
    v_mul_f32 v83, v3, v83
    v_mul_f32 v116, v3, v116
    v_mul_f32 v117, v3, v117
    v_mul_f32 v118, v3, v118
    v_mul_f32 v119, v3, v119
    s_add_u32 s40, s21, 7
    s_cmp_ge_u32 s40, 9
    s_cselect_b32 s41, 9, 0
    s_sub_u32 s40, s40, s41
    s_lshl_b32 s40, s40, 6
    v_add_u32 v2, s40, v33
    ds_read_b32 v3, v2 offset:640
    s_waitcnt lgkmcnt(0)
    v_mul_f32 v84, v3, v84
    v_mul_f32 v85, v3, v85
    v_mul_f32 v86, v3, v86
    v_mul_f32 v87, v3, v87
    v_mul_f32 v120, v3, v120
    v_mul_f32 v121, v3, v121
    v_mul_f32 v122, v3, v122
    v_mul_f32 v123, v3, v123
    s_add_u32 s40, s21, 8
    s_cmp_ge_u32 s40, 9
    s_cselect_b32 s41, 9, 0
    s_sub_u32 s40, s40, s41
    s_lshl_b32 s40, s40, 6
    v_add_u32 v2, s40, v33
    ds_read_b32 v3, v2 offset:640
    s_waitcnt lgkmcnt(0)
    v_mul_f32 v88, v3, v88
    v_mul_f32 v89, v3, v89
    v_mul_f32 v90, v3, v90
    v_mul_f32 v91, v3, v91
    v_mul_f32 v124, v3, v124
    v_mul_f32 v125, v3, v125
    v_mul_f32 v126, v3, v126
    v_mul_f32 v127, v3, v127
    s_nop 1
    s_branch K_rs21
R_yfin2:
    s_lshl_b32 s40, s21, 6
    v_add_u32 v1, s40, v34
    s_mul_i32 s40, s21, 144
    v_subrev_u32 v2, s40, v1
    ds_read_b32 v128, v1 offset:0
    ds_read_b32 v129, v1 offset:64
    ds_read_b32 v130, v1 offset:128
    ds_read_b32 v131, v1 offset:192
    ds_read_b32 v132, v1 offset:256
    ds_read_b32 v133, v2 offset:320
    ds_read_b32 v134, v2 offset:384
    ds_read_b32 v135, v2 offset:448
    ds_read_b32 v136, v2 offset:512
    s_waitcnt lgkmcnt(8)
    v_mul_f32 v56, v128, v56
    v_mul_f32 v57, v128, v57
    v_mul_f32 v58, v128, v58
    v_mul_f32 v59, v128, v59
    v_cvt_pk_bf16_f32 v156, v56, v57
    v_cvt_pk_bf16_f32 v157, v58, v59
    v_mul_f32 v92, v128, v92
    v_mul_f32 v93, v128, v93
    v_mul_f32 v94, v128, v94
    v_mul_f32 v95, v128, v95
    v_cvt_pk_bf16_f32 v158, v92, v93
    v_cvt_pk_bf16_f32 v159, v94, v95
    s_waitcnt lgkmcnt(7)
    v_mul_f32 v60, v129, v60
    v_mul_f32 v61, v129, v61
    v_mul_f32 v62, v129, v62
    v_mul_f32 v63, v129, v63
    v_cvt_pk_bf16_f32 v160, v60, v61
    v_cvt_pk_bf16_f32 v161, v62, v63
    v_mul_f32 v96, v129, v96
    v_mul_f32 v97, v129, v97
    v_mul_f32 v98, v129, v98
    v_mul_f32 v99, v129, v99
    v_cvt_pk_bf16_f32 v162, v96, v97
    v_cvt_pk_bf16_f32 v163, v98, v99
    s_waitcnt lgkmcnt(6)
    v_mul_f32 v64, v130, v64
    v_mul_f32 v65, v130, v65
    v_mul_f32 v66, v130, v66
    v_mul_f32 v67, v130, v67
    v_cvt_pk_bf16_f32 v164, v64, v65
    v_cvt_pk_bf16_f32 v165, v66, v67
    v_mul_f32 v100, v130, v100
    v_mul_f32 v101, v130, v101
    v_mul_f32 v102, v130, v102
    v_mul_f32 v103, v130, v103
    v_cvt_pk_bf16_f32 v166, v100, v101
    v_cvt_pk_bf16_f32 v167, v102, v103
    s_waitcnt lgkmcnt(5)
    v_mul_f32 v68, v131, v68
    v_mul_f32 v69, v131, v69
    v_mul_f32 v70, v131, v70
    v_mul_f32 v71, v131, v71
    v_cvt_pk_bf16_f32 v168, v68, v69
    v_cvt_pk_bf16_f32 v169, v70, v71
    v_mul_f32 v104, v131, v104
    v_mul_f32 v105, v131, v105
    v_mul_f32 v106, v131, v106
    v_mul_f32 v107, v131, v107
    v_cvt_pk_bf16_f32 v170, v104, v105
    v_cvt_pk_bf16_f32 v171, v106, v107
    s_waitcnt lgkmcnt(4)
    v_mul_f32 v72, v132, v72
    v_mul_f32 v73, v132, v73
    v_mul_f32 v74, v132, v74
    v_mul_f32 v75, v132, v75
    v_cvt_pk_bf16_f32 v172, v72, v73
    v_cvt_pk_bf16_f32 v173, v74, v75
    v_mul_f32 v108, v132, v108
    v_mul_f32 v109, v132, v109
    v_mul_f32 v110, v132, v110
    v_mul_f32 v111, v132, v111
    v_cvt_pk_bf16_f32 v174, v108, v109
    v_cvt_pk_bf16_f32 v175, v110, v111
    s_waitcnt lgkmcnt(3)
    v_mul_f32 v76, v133, v76
    v_mul_f32 v77, v133, v77
    v_mul_f32 v78, v133, v78
    v_mul_f32 v79, v133, v79
    v_cvt_pk_bf16_f32 v176, v76, v77
    v_cvt_pk_bf16_f32 v177, v78, v79
    v_mul_f32 v112, v133, v112
    v_mul_f32 v113, v133, v113
    v_mul_f32 v114, v133, v114
    v_mul_f32 v115, v133, v115
    v_cvt_pk_bf16_f32 v178, v112, v113
    v_cvt_pk_bf16_f32 v179, v114, v115
    s_waitcnt lgkmcnt(2)
    v_mul_f32 v80, v134, v80
    v_mul_f32 v81, v134, v81
    v_mul_f32 v82, v134, v82
    v_mul_f32 v83, v134, v83
    v_cvt_pk_bf16_f32 v180, v80, v81
    v_cvt_pk_bf16_f32 v181, v82, v83
    v_mul_f32 v116, v134, v116
    v_mul_f32 v117, v134, v117
    v_mul_f32 v118, v134, v118
    v_mul_f32 v119, v134, v119
    v_cvt_pk_bf16_f32 v182, v116, v117
    v_cvt_pk_bf16_f32 v183, v118, v119
    s_waitcnt lgkmcnt(1)
    v_mul_f32 v84, v135, v84
    v_mul_f32 v85, v135, v85
    v_mul_f32 v86, v135, v86
    v_mul_f32 v87, v135, v87
    v_cvt_pk_bf16_f32 v12, v84, v85
    v_cvt_pk_bf16_f32 v13, v86, v87
    v_mul_f32 v120, v135, v120
    v_mul_f32 v121, v135, v121
    v_mul_f32 v122, v135, v122
    v_mul_f32 v123, v135, v123
    v_cvt_pk_bf16_f32 v14, v120, v121
    v_cvt_pk_bf16_f32 v15, v122, v123
    s_waitcnt lgkmcnt(0)
    v_mul_f32 v88, v136, v88
    v_mul_f32 v89, v136, v89
    v_mul_f32 v90, v136, v90
    v_mul_f32 v91, v136, v91
    v_cvt_pk_bf16_f32 v16, v88, v89
    v_cvt_pk_bf16_f32 v17, v90, v91
    v_mul_f32 v124, v136, v124
    v_mul_f32 v125, v136, v125
    v_mul_f32 v126, v136, v126
    v_mul_f32 v127, v136, v127
    v_cvt_pk_bf16_f32 v18, v124, v125
    v_cvt_pk_bf16_f32 v19, v126, v127
    s_branch K_yfin2
R_rs30:
    s_nop 7
    s_add_u32 s40, s21, 0
    s_cmp_ge_u32 s40, 9
    s_cselect_b32 s41, 9, 0
    s_sub_u32 s40, s40, s41
    s_lshl_b32 s40, s40, 6
    v_add_u32 v2, s40, v33
    ds_read_b32 v3, v2 offset:0
    s_waitcnt lgkmcnt(0)
    v_mul_f32 v56, v3, v56
    v_mul_f32 v57, v3, v57
    v_mul_f32 v58, v3, v58
    v_mul_f32 v59, v3, v59
    v_mul_f32 v92, v3, v92
    v_mul_f32 v93, v3, v93
    v_mul_f32 v94, v3, v94
    v_mul_f32 v95, v3, v95
    v_mul_f32 v128, v3, v128
    v_mul_f32 v129, v3, v129
    v_mul_f32 v130, v3, v130
    v_mul_f32 v131, v3, v131
    v_mul_f32 v148, v3, v148
    v_mul_f32 v149, v3, v149
    v_mul_f32 v150, v3, v150
    v_mul_f32 v151, v3, v151
    s_add_u32 s40, s21, 1
    s_cmp_ge_u32 s40, 9
    s_cselect_b32 s41, 9, 0
    s_sub_u32 s40, s40, s41
    s_lshl_b32 s40, s40, 6
    v_add_u32 v2, s40, v33
    ds_read_b32 v3, v2 offset:0
    s_waitcnt lgkmcnt(0)
    v_mul_f32 v60, v3, v60
    v_mul_f32 v61, v3, v61
    v_mul_f32 v62, v3, v62
    v_mul_f32 v63, v3, v63
    v_mul_f32 v96, v3, v96
    v_mul_f32 v97, v3, v97
    v_mul_f32 v98, v3, v98
    v_mul_f32 v99, v3, v99
    v_mul_f32 v132, v3, v132
    v_mul_f32 v133, v3, v133
    v_mul_f32 v134, v3, v134
    v_mul_f32 v135, v3, v135
    v_mul_f32 v152, v3, v152
    v_mul_f32 v153, v3, v153
    v_mul_f32 v154, v3, v154
    v_mul_f32 v155, v3, v155
    s_add_u32 s40, s21, 2
    s_cmp_ge_u32 s40, 9
    s_cselect_b32 s41, 9, 0
    s_sub_u32 s40, s40, s41
    s_lshl_b32 s40, s40, 6
    v_add_u32 v2, s40, v33
    ds_read_b32 v3, v2 offset:0
    s_waitcnt lgkmcnt(0)
    v_mul_f32 v64, v3, v64
    v_mul_f32 v65, v3, v65
    v_mul_f32 v66, v3, v66
    v_mul_f32 v67, v3, v67
    v_mul_f32 v100, v3, v100
    v_mul_f32 v101, v3, v101
    v_mul_f32 v102, v3, v102
    v_mul_f32 v103, v3, v103
    v_mul_f32 v136, v3, v136
    v_mul_f32 v137, v3, v137
    v_mul_f32 v138, v3, v138
    v_mul_f32 v139, v3, v139
    v_mul_f32 v156, v3, v156
    v_mul_f32 v157, v3, v157
    v_mul_f32 v158, v3, v158
    v_mul_f32 v159, v3, v159
    s_add_u32 s40, s21, 3
    s_cmp_ge_u32 s40, 9
    s_cselect_b32 s41, 9, 0
    s_sub_u32 s40, s40, s41
    s_lshl_b32 s40, s40, 6
    v_add_u32 v2, s40, v33
    ds_read_b32 v3, v2 offset:0
    s_waitcnt lgkmcnt(0)
    v_mul_f32 v68, v3, v68
    v_mul_f32 v69, v3, v69
    v_mul_f32 v70, v3, v70
    v_mul_f32 v71, v3, v71
    v_mul_f32 v104, v3, v104
    v_mul_f32 v105, v3, v105
    v_mul_f32 v106, v3, v106
    v_mul_f32 v107, v3, v107
    v_mul_f32 v140, v3, v140
    v_mul_f32 v141, v3, v141
    v_mul_f32 v142, v3, v142
    v_mul_f32 v143, v3, v143
    v_mul_f32 v160, v3, v160
    v_mul_f32 v161, v3, v161
    v_mul_f32 v162, v3, v162
    v_mul_f32 v163, v3, v163
    s_add_u32 s40, s21, 4
    s_cmp_ge_u32 s40, 9
    s_cselect_b32 s41, 9, 0
    s_sub_u32 s40, s40, s41
    s_lshl_b32 s40, s40, 6
    v_add_u32 v2, s40, v33
    ds_read_b32 v3, v2 offset:0
    s_waitcnt lgkmcnt(0)
    v_mul_f32 v72, v3, v72
    v_mul_f32 v73, v3, v73
    v_mul_f32 v74, v3, v74
    v_mul_f32 v75, v3, v75
    v_mul_f32 v108, v3, v108
    v_mul_f32 v109, v3, v109
    v_mul_f32 v110, v3, v110
    v_mul_f32 v111, v3, v111
    v_mul_f32 v144, v3, v144
    v_mul_f32 v145, v3, v145
    v_mul_f32 v146, v3, v146
    v_mul_f32 v147, v3, v147
    v_mul_f32 v164, v3, v164
    v_mul_f32 v165, v3, v165
    v_mul_f32 v166, v3, v166
    v_mul_f32 v167, v3, v167
    s_add_u32 s40, s21, 5
    s_cmp_ge_u32 s40, 9
    s_cselect_b32 s41, 9, 0
    s_sub_u32 s40, s40, s41
    s_lshl_b32 s40, s40, 6
    v_add_u32 v2, s40, v33
    ds_read_b32 v3, v2 offset:0
    s_waitcnt lgkmcnt(0)
    v_mul_f32 v76, v3, v76
    v_mul_f32 v77, v3, v77
    v_mul_f32 v78, v3, v78
    v_mul_f32 v79, v3, v79
    v_mul_f32 v112, v3, v112
    v_mul_f32 v113, v3, v113
    v_mul_f32 v114, v3, v114
    v_mul_f32 v115, v3, v115
    s_add_u32 s40, s21, 6
    s_cmp_ge_u32 s40, 9
    s_cselect_b32 s41, 9, 0
    s_sub_u32 s40, s40, s41
    s_lshl_b32 s40, s40, 6
    v_add_u32 v2, s40, v33
    ds_read_b32 v3, v2 offset:0
    s_waitcnt lgkmcnt(0)
    v_mul_f32 v80, v3, v80
    v_mul_f32 v81, v3, v81
    v_mul_f32 v82, v3, v82
    v_mul_f32 v83, v3, v83
    v_mul_f32 v116, v3, v116
    v_mul_f32 v117, v3, v117
    v_mul_f32 v118, v3, v118
    v_mul_f32 v119, v3, v119
    s_add_u32 s40, s21, 7
    s_cmp_ge_u32 s40, 9
    s_cselect_b32 s41, 9, 0
    s_sub_u32 s40, s40, s41
    s_lshl_b32 s40, s40, 6
    v_add_u32 v2, s40, v33
    ds_read_b32 v3, v2 offset:0
    s_waitcnt lgkmcnt(0)
    v_mul_f32 v84, v3, v84
    v_mul_f32 v85, v3, v85
    v_mul_f32 v86, v3, v86
    v_mul_f32 v87, v3, v87
    v_mul_f32 v120, v3, v120
    v_mul_f32 v121, v3, v121
    v_mul_f32 v122, v3, v122
    v_mul_f32 v123, v3, v123
    s_add_u32 s40, s21, 8
    s_cmp_ge_u32 s40, 9
    s_cselect_b32 s41, 9, 0
    s_sub_u32 s40, s40, s41
    s_lshl_b32 s40, s40, 6
    v_add_u32 v2, s40, v33
    ds_read_b32 v3, v2 offset:0
    s_waitcnt lgkmcnt(0)
    v_mul_f32 v88, v3, v88
    v_mul_f32 v89, v3, v89
    v_mul_f32 v90, v3, v90
    v_mul_f32 v91, v3, v91
    v_mul_f32 v124, v3, v124
    v_mul_f32 v125, v3, v125
    v_mul_f32 v126, v3, v126
    v_mul_f32 v127, v3, v127
    s_nop 1
    s_branch K_rs30
R_rs31:
    s_nop 7
    s_add_u32 s40, s21, 0
    s_cmp_ge_u32 s40, 9
    s_cselect_b32 s41, 9, 0
    s_sub_u32 s40, s40, s41
    s_lshl_b32 s40, s40, 6
    v_add_u32 v2, s40, v33
    ds_read_b32 v3, v2 offset:640
    s_waitcnt lgkmcnt(0)
    v_mul_f32 v56, v3, v56
    v_mul_f32 v57, v3, v57
    v_mul_f32 v58, v3, v58
    v_mul_f32 v59, v3, v59
    v_mul_f32 v92, v3, v92
    v_mul_f32 v93, v3, v93
    v_mul_f32 v94, v3, v94
    v_mul_f32 v95, v3, v95
    v_mul_f32 v128, v3, v128
    v_mul_f32 v129, v3, v129
    v_mul_f32 v130, v3, v130
    v_mul_f32 v131, v3, v131
    v_mul_f32 v148, v3, v148
    v_mul_f32 v149, v3, v149
    v_mul_f32 v150, v3, v150
    v_mul_f32 v151, v3, v151
    s_add_u32 s40, s21, 1
    s_cmp_ge_u32 s40, 9
    s_cselect_b32 s41, 9, 0
    s_sub_u32 s40, s40, s41
    s_lshl_b32 s40, s40, 6
    v_add_u32 v2, s40, v33
    ds_read_b32 v3, v2 offset:640
    s_waitcnt lgkmcnt(0)
    v_mul_f32 v60, v3, v60
    v_mul_f32 v61, v3, v61
    v_mul_f32 v62, v3, v62
    v_mul_f32 v63, v3, v63
    v_mul_f32 v96, v3, v96
    v_mul_f32 v97, v3, v97
    v_mul_f32 v98, v3, v98
    v_mul_f32 v99, v3, v99
    v_mul_f32 v132, v3, v132
    v_mul_f32 v133, v3, v133
    v_mul_f32 v134, v3, v134
    v_mul_f32 v135, v3, v135
    v_mul_f32 v152, v3, v152
    v_mul_f32 v153, v3, v153
    v_mul_f32 v154, v3, v154
    v_mul_f32 v155, v3, v155
    s_add_u32 s40, s21, 2
    s_cmp_ge_u32 s40, 9
    s_cselect_b32 s41, 9, 0
    s_sub_u32 s40, s40, s41
    s_lshl_b32 s40, s40, 6
    v_add_u32 v2, s40, v33
    ds_read_b32 v3, v2 offset:640
    s_waitcnt lgkmcnt(0)
    v_mul_f32 v64, v3, v64
    v_mul_f32 v65, v3, v65
    v_mul_f32 v66, v3, v66
    v_mul_f32 v67, v3, v67
    v_mul_f32 v100, v3, v100
    v_mul_f32 v101, v3, v101
    v_mul_f32 v102, v3, v102
    v_mul_f32 v103, v3, v103
    v_mul_f32 v136, v3, v136
    v_mul_f32 v137, v3, v137
    v_mul_f32 v138, v3, v138
    v_mul_f32 v139, v3, v139
    v_mul_f32 v156, v3, v156
    v_mul_f32 v157, v3, v157
    v_mul_f32 v158, v3, v158
    v_mul_f32 v159, v3, v159
    s_add_u32 s40, s21, 3
    s_cmp_ge_u32 s40, 9
    s_cselect_b32 s41, 9, 0
    s_sub_u32 s40, s40, s41
    s_lshl_b32 s40, s40, 6
    v_add_u32 v2, s40, v33
    ds_read_b32 v3, v2 offset:640
    s_waitcnt lgkmcnt(0)
    v_mul_f32 v68, v3, v68
    v_mul_f32 v69, v3, v69
    v_mul_f32 v70, v3, v70
    v_mul_f32 v71, v3, v71
    v_mul_f32 v104, v3, v104
    v_mul_f32 v105, v3, v105
    v_mul_f32 v106, v3, v106
    v_mul_f32 v107, v3, v107
    v_mul_f32 v140, v3, v140
    v_mul_f32 v141, v3, v141
    v_mul_f32 v142, v3, v142
    v_mul_f32 v143, v3, v143
    v_mul_f32 v160, v3, v160
    v_mul_f32 v161, v3, v161
    v_mul_f32 v162, v3, v162
    v_mul_f32 v163, v3, v163
    s_add_u32 s40, s21, 4
    s_cmp_ge_u32 s40, 9
    s_cselect_b32 s41, 9, 0
    s_sub_u32 s40, s40, s41
    s_lshl_b32 s40, s40, 6
    v_add_u32 v2, s40, v33
    ds_read_b32 v3, v2 offset:640
    s_waitcnt lgkmcnt(0)
    v_mul_f32 v72, v3, v72
    v_mul_f32 v73, v3, v73
    v_mul_f32 v74, v3, v74
    v_mul_f32 v75, v3, v75
    v_mul_f32 v108, v3, v108
    v_mul_f32 v109, v3, v109
    v_mul_f32 v110, v3, v110
    v_mul_f32 v111, v3, v111
    v_mul_f32 v144, v3, v144
    v_mul_f32 v145, v3, v145
    v_mul_f32 v146, v3, v146
    v_mul_f32 v147, v3, v147
    v_mul_f32 v164, v3, v164
    v_mul_f32 v165, v3, v165
    v_mul_f32 v166, v3, v166
    v_mul_f32 v167, v3, v167
    s_add_u32 s40, s21, 5
    s_cmp_ge_u32 s40, 9
    s_cselect_b32 s41, 9, 0
    s_sub_u32 s40, s40, s41
    s_lshl_b32 s40, s40, 6
    v_add_u32 v2, s40, v33
    ds_read_b32 v3, v2 offset:640
    s_waitcnt lgkmcnt(0)
    v_mul_f32 v76, v3, v76
    v_mul_f32 v77, v3, v77
    v_mul_f32 v78, v3, v78
    v_mul_f32 v79, v3, v79
    v_mul_f32 v112, v3, v112
    v_mul_f32 v113, v3, v113
    v_mul_f32 v114, v3, v114
    v_mul_f32 v115, v3, v115
    s_add_u32 s40, s21, 6
    s_cmp_ge_u32 s40, 9
    s_cselect_b32 s41, 9, 0
    s_sub_u32 s40, s40, s41
    s_lshl_b32 s40, s40, 6
    v_add_u32 v2, s40, v33
    ds_read_b32 v3, v2 offset:640
    s_waitcnt lgkmcnt(0)
    v_mul_f32 v80, v3, v80
    v_mul_f32 v81, v3, v81
    v_mul_f32 v82, v3, v82
    v_mul_f32 v83, v3, v83
    v_mul_f32 v116, v3, v116
    v_mul_f32 v117, v3, v117
    v_mul_f32 v118, v3, v118
    v_mul_f32 v119, v3, v119
    s_add_u32 s40, s21, 7
    s_cmp_ge_u32 s40, 9
    s_cselect_b32 s41, 9, 0
    s_sub_u32 s40, s40, s41
    s_lshl_b32 s40, s40, 6
    v_add_u32 v2, s40, v33
    ds_read_b32 v3, v2 offset:640
    s_waitcnt lgkmcnt(0)
    v_mul_f32 v84, v3, v84
    v_mul_f32 v85, v3, v85
    v_mul_f32 v86, v3, v86
    v_mul_f32 v87, v3, v87
    v_mul_f32 v120, v3, v120
    v_mul_f32 v121, v3, v121
    v_mul_f32 v122, v3, v122
    v_mul_f32 v123, v3, v123
    s_add_u32 s40, s21, 8
    s_cmp_ge_u32 s40, 9
    s_cselect_b32 s41, 9, 0
    s_sub_u32 s40, s40, s41
    s_lshl_b32 s40, s40, 6
    v_add_u32 v2, s40, v33
    ds_read_b32 v3, v2 offset:640
    s_waitcnt lgkmcnt(0)
    v_mul_f32 v88, v3, v88
    v_mul_f32 v89, v3, v89
    v_mul_f32 v90, v3, v90
    v_mul_f32 v91, v3, v91
    v_mul_f32 v124, v3, v124
    v_mul_f32 v125, v3, v125
    v_mul_f32 v126, v3, v126
    v_mul_f32 v127, v3, v127
    s_nop 1
    s_branch K_rs31
R_yfin3:
    s_lshl_b32 s40, s21, 6
    v_add_u32 v1, s40, v34
    s_mul_i32 s40, s21, 144
    v_subrev_u32 v2, s40, v1
    ds_read_b32 v168, v1 offset:0
    ds_read_b32 v169, v1 offset:64
    ds_read_b32 v170, v1 offset:128
    ds_read_b32 v171, v1 offset:192
    ds_read_b32 v172, v1 offset:256
    ds_read_b32 v173, v2 offset:320
    ds_read_b32 v174, v2 offset:384
    ds_read_b32 v175, v2 offset:448
    ds_read_b32 v176, v2 offset:512
    s_waitcnt lgkmcnt(8)
    v_mul_f32 v56, v168, v56
    v_mul_f32 v57, v168, v57
    v_mul_f32 v58, v168, v58
    v_mul_f32 v59, v168, v59
    v_cvt_pk_bf16_f32 v200, v56, v57
    v_cvt_pk_bf16_f32 v201, v58, v59
    v_mul_f32 v92, v168, v92
    v_mul_f32 v93, v168, v93
    v_mul_f32 v94, v168, v94
    v_mul_f32 v95, v168, v95
    v_cvt_pk_bf16_f32 v202, v92, v93
    v_cvt_pk_bf16_f32 v203, v94, v95
    s_waitcnt lgkmcnt(7)
    v_mul_f32 v60, v169, v60
    v_mul_f32 v61, v169, v61
    v_mul_f32 v62, v169, v62
    v_mul_f32 v63, v169, v63
    v_cvt_pk_bf16_f32 v204, v60, v61
    v_cvt_pk_bf16_f32 v205, v62, v63
    v_mul_f32 v96, v169, v96
    v_mul_f32 v97, v169, v97
    v_mul_f32 v98, v169, v98
    v_mul_f32 v99, v169, v99
    v_cvt_pk_bf16_f32 v206, v96, v97
    v_cvt_pk_bf16_f32 v207, v98, v99
    s_waitcnt lgkmcnt(6)
    v_mul_f32 v64, v170, v64
    v_mul_f32 v65, v170, v65
    v_mul_f32 v66, v170, v66
    v_mul_f32 v67, v170, v67
    v_cvt_pk_bf16_f32 v208, v64, v65
    v_cvt_pk_bf16_f32 v209, v66, v67
    v_mul_f32 v100, v170, v100
    v_mul_f32 v101, v170, v101
    v_mul_f32 v102, v170, v102
    v_mul_f32 v103, v170, v103
    v_cvt_pk_bf16_f32 v210, v100, v101
    v_cvt_pk_bf16_f32 v211, v102, v103
    s_waitcnt lgkmcnt(5)
    v_mul_f32 v68, v171, v68
    v_mul_f32 v69, v171, v69
    v_mul_f32 v70, v171, v70
    v_mul_f32 v71, v171, v71
    v_cvt_pk_bf16_f32 v212, v68, v69
    v_cvt_pk_bf16_f32 v213, v70, v71
    v_mul_f32 v104, v171, v104
    v_mul_f32 v105, v171, v105
    v_mul_f32 v106, v171, v106
    v_mul_f32 v107, v171, v107
    v_cvt_pk_bf16_f32 v214, v104, v105
    v_cvt_pk_bf16_f32 v215, v106, v107
    s_waitcnt lgkmcnt(4)
    v_mul_f32 v72, v172, v72
    v_mul_f32 v73, v172, v73
    v_mul_f32 v74, v172, v74
    v_mul_f32 v75, v172, v75
    v_cvt_pk_bf16_f32 v216, v72, v73
    v_cvt_pk_bf16_f32 v217, v74, v75
    v_mul_f32 v108, v172, v108
    v_mul_f32 v109, v172, v109
    v_mul_f32 v110, v172, v110
    v_mul_f32 v111, v172, v111
    v_cvt_pk_bf16_f32 v218, v108, v109
    v_cvt_pk_bf16_f32 v219, v110, v111
    s_waitcnt lgkmcnt(3)
    v_mul_f32 v76, v173, v76
    v_mul_f32 v77, v173, v77
    v_mul_f32 v78, v173, v78
    v_mul_f32 v79, v173, v79
    v_cvt_pk_bf16_f32 v232, v76, v77
    v_cvt_pk_bf16_f32 v233, v78, v79
    v_mul_f32 v112, v173, v112
    v_mul_f32 v113, v173, v113
    v_mul_f32 v114, v173, v114
    v_mul_f32 v115, v173, v115
    v_cvt_pk_bf16_f32 v234, v112, v113
    v_cvt_pk_bf16_f32 v235, v114, v115
    s_waitcnt lgkmcnt(2)
    v_mul_f32 v80, v174, v80
    v_mul_f32 v81, v174, v81
    v_mul_f32 v82, v174, v82
    v_mul_f32 v83, v174, v83
    v_cvt_pk_bf16_f32 v236, v80, v81
    v_cvt_pk_bf16_f32 v237, v82, v83
    v_mul_f32 v116, v174, v116
    v_mul_f32 v117, v174, v117
    v_mul_f32 v118, v174, v118
    v_mul_f32 v119, v174, v119
    v_cvt_pk_bf16_f32 v238, v116, v117
    v_cvt_pk_bf16_f32 v239, v118, v119
    s_waitcnt lgkmcnt(1)
    v_mul_f32 v84, v175, v84
    v_mul_f32 v85, v175, v85
    v_mul_f32 v86, v175, v86
    v_mul_f32 v87, v175, v87
    v_cvt_pk_bf16_f32 v240, v84, v85
    v_cvt_pk_bf16_f32 v241, v86, v87
    v_mul_f32 v120, v175, v120
    v_mul_f32 v121, v175, v121
    v_mul_f32 v122, v175, v122
    v_mul_f32 v123, v175, v123
    v_cvt_pk_bf16_f32 v242, v120, v121
    v_cvt_pk_bf16_f32 v243, v122, v123
    s_waitcnt lgkmcnt(0)
    v_mul_f32 v88, v176, v88
    v_mul_f32 v89, v176, v89
    v_mul_f32 v90, v176, v90
    v_mul_f32 v91, v176, v91
    v_cvt_pk_bf16_f32 v244, v88, v89
    v_cvt_pk_bf16_f32 v245, v90, v91
    v_mul_f32 v124, v176, v124
    v_mul_f32 v125, v176, v125
    v_mul_f32 v126, v176, v126
    v_mul_f32 v127, v176, v127
    v_cvt_pk_bf16_f32 v246, v124, v125
    v_cvt_pk_bf16_f32 v247, v126, v127
    v_mul_f32 v128, v168, v128
    v_mul_f32 v129, v168, v129
    v_mul_f32 v130, v168, v130
    v_mul_f32 v131, v168, v131
    v_cvt_pk_bf16_f32 v248, v128, v129
    v_cvt_pk_bf16_f32 v249, v130, v131
    v_mul_f32 v148, v168, v148
    v_mul_f32 v149, v168, v149
    v_mul_f32 v150, v168, v150
    v_mul_f32 v151, v168, v151
    v_cvt_pk_bf16_f32 v250, v148, v149
    v_cvt_pk_bf16_f32 v251, v150, v151
    v_mul_f32 v132, v169, v132
    v_mul_f32 v133, v169, v133
    v_mul_f32 v134, v169, v134
    v_mul_f32 v135, v169, v135
    v_cvt_pk_bf16_f32 v252, v132, v133
    v_cvt_pk_bf16_f32 v253, v134, v135
    v_mul_f32 v152, v169, v152
    v_mul_f32 v153, v169, v153
    v_mul_f32 v154, v169, v154
    v_mul_f32 v155, v169, v155
    v_cvt_pk_bf16_f32 v254, v152, v153
    v_cvt_pk_bf16_f32 v255, v154, v155
    v_mul_f32 v136, v170, v136
    v_mul_f32 v137, v170, v137
    v_mul_f32 v138, v170, v138
    v_mul_f32 v139, v170, v139
    v_cvt_pk_bf16_f32 v12, v136, v137
    v_cvt_pk_bf16_f32 v13, v138, v139
    v_mul_f32 v156, v170, v156
    v_mul_f32 v157, v170, v157
    v_mul_f32 v158, v170, v158
    v_mul_f32 v159, v170, v159
    v_cvt_pk_bf16_f32 v14, v156, v157
    v_cvt_pk_bf16_f32 v15, v158, v159
    v_mul_f32 v140, v171, v140
    v_mul_f32 v141, v171, v141
    v_mul_f32 v142, v171, v142
    v_mul_f32 v143, v171, v143
    v_cvt_pk_bf16_f32 v16, v140, v141
    v_cvt_pk_bf16_f32 v17, v142, v143
    v_mul_f32 v160, v171, v160
    v_mul_f32 v161, v171, v161
    v_mul_f32 v162, v171, v162
    v_mul_f32 v163, v171, v163
    v_cvt_pk_bf16_f32 v18, v160, v161
    v_cvt_pk_bf16_f32 v19, v162, v163
    v_mul_f32 v144, v172, v144
    v_mul_f32 v145, v172, v145
    v_mul_f32 v146, v172, v146
    v_mul_f32 v147, v172, v147
    v_cvt_pk_bf16_f32 v196, v144, v145
    v_cvt_pk_bf16_f32 v197, v146, v147
    v_mul_f32 v164, v172, v164
    v_mul_f32 v165, v172, v165
    v_mul_f32 v166, v172, v166
    v_mul_f32 v167, v172, v167
    v_cvt_pk_bf16_f32 v198, v164, v165
    v_cvt_pk_bf16_f32 v199, v166, v167
    s_cmp_eq_u32 s50, 16
    s_cbranch_scc1 K_yfin3
    v_mov_b32 v56, 0
    v_mov_b32 v57, 0
    v_mov_b32 v58, 0
    v_mov_b32 v59, 0
    v_mov_b32 v60, 0
    v_mov_b32 v61, 0
    v_mov_b32 v62, 0
    v_mov_b32 v63, 0
    v_mov_b32 v64, 0
    v_mov_b32 v65, 0
    v_mov_b32 v66, 0
    v_mov_b32 v67, 0
    v_mov_b32 v68, 0
    v_mov_b32 v69, 0
    v_mov_b32 v70, 0
    v_mov_b32 v71, 0
    v_mov_b32 v72, 0
    v_mov_b32 v73, 0
    v_mov_b32 v74, 0
    v_mov_b32 v75, 0
    v_mov_b32 v76, 0
    v_mov_b32 v77, 0
    v_mov_b32 v78, 0
    v_mov_b32 v79, 0
    v_mov_b32 v80, 0
    v_mov_b32 v81, 0
    v_mov_b32 v82, 0
    v_mov_b32 v83, 0
    v_mov_b32 v84, 0
    v_mov_b32 v85, 0
    v_mov_b32 v86, 0
    v_mov_b32 v87, 0
    v_mov_b32 v88, 0
    v_mov_b32 v89, 0
    v_mov_b32 v90, 0
    v_mov_b32 v91, 0
    v_mov_b32 v92, 0
    v_mov_b32 v93, 0
    v_mov_b32 v94, 0
    v_mov_b32 v95, 0
    v_mov_b32 v96, 0
    v_mov_b32 v97, 0
    v_mov_b32 v98, 0
    v_mov_b32 v99, 0
    v_mov_b32 v100, 0
    v_mov_b32 v101, 0
    v_mov_b32 v102, 0
    v_mov_b32 v103, 0
    v_mov_b32 v104, 0
    v_mov_b32 v105, 0
    v_mov_b32 v106, 0
    v_mov_b32 v107, 0
    v_mov_b32 v108, 0
    v_mov_b32 v109, 0
    v_mov_b32 v110, 0
    v_mov_b32 v111, 0
    v_mov_b32 v112, 0
    v_mov_b32 v113, 0
    v_mov_b32 v114, 0
    v_mov_b32 v115, 0
    v_mov_b32 v116, 0
    v_mov_b32 v117, 0
    v_mov_b32 v118, 0
    v_mov_b32 v119, 0
    v_mov_b32 v120, 0
    v_mov_b32 v121, 0
    v_mov_b32 v122, 0
    v_mov_b32 v123, 0
    v_mov_b32 v124, 0
    v_mov_b32 v125, 0
    v_mov_b32 v126, 0
    v_mov_b32 v127, 0
    v_mov_b32 v128, 0
    v_mov_b32 v129, 0
    v_mov_b32 v130, 0
    v_mov_b32 v131, 0
    v_mov_b32 v132, 0
    v_mov_b32 v133, 0
    v_mov_b32 v134, 0
    v_mov_b32 v135, 0
    v_mov_b32 v136, 0
    v_mov_b32 v137, 0
    v_mov_b32 v138, 0
    v_mov_b32 v139, 0
    v_mov_b32 v140, 0
    v_mov_b32 v141, 0
    v_mov_b32 v142, 0
    v_mov_b32 v143, 0
    v_mov_b32 v144, 0
    v_mov_b32 v145, 0
    v_mov_b32 v146, 0
    v_mov_b32 v147, 0
    v_mov_b32 v148, 0
    v_mov_b32 v149, 0
    v_mov_b32 v150, 0
    v_mov_b32 v151, 0
    v_mov_b32 v152, 0
    v_mov_b32 v153, 0
    v_mov_b32 v154, 0
    v_mov_b32 v155, 0
    v_mov_b32 v156, 0
    v_mov_b32 v157, 0
    v_mov_b32 v158, 0
    v_mov_b32 v159, 0
    v_mov_b32 v160, 0
    v_mov_b32 v161, 0
    v_mov_b32 v162, 0
    v_mov_b32 v163, 0
    v_mov_b32 v164, 0
    v_mov_b32 v165, 0
    v_mov_b32 v166, 0
    v_mov_b32 v167, 0
    s_branch K_yfin3
R_ost:
    s_cmp_eq_u32 s50, 16
    s_cbranch_scc1 svc_st
    s_cmp_eq_u32 s50, 8
    s_cbranch_scc1 svc8
    s_cmp_eq_u32 s50, 9
    s_cbranch_scc1 svc9
    s_cmp_eq_u32 s50, 10
    s_cbranch_scc1 svc10
    s_cmp_eq_u32 s50, 11
    s_cbranch_scc1 svc11
    s_cmp_eq_u32 s50, 12
    s_cbranch_scc1 svc12
    s_cmp_eq_u32 s50, 13
    s_cbranch_scc1 svc13
    s_cmp_eq_u32 s50, 14
    s_cbranch_scc1 svc14
    s_cmp_eq_u32 s50, 15
    s_cbranch_scc1 svc15
    s_branch K_ost
svc11:
    s_waitcnt vmcnt(0)
    s_cmp_lg_u32 s32, 3
    s_cbranch_scc1 K_ost
    s_lshl_b32 s40, s28, 4
    s_mov_b32 s42, 0x40000
    v_mov_b32 v1, 0
pl3:
    buffer_load_dwordx4 v[4:7], v1, s[76:79], s40 offen sc1
    s_waitcnt vmcnt(0)
    v_min3_u32 v4, v4, v5, v6
    v_min_u32 v4, v4, v7
    s_nop 0
    v_readfirstlane_b32 s41, v4
    s_nop 0
    s_cmp_eq_u32 s41, 1
    s_cbranch_scc1 pl3_ok
    s_sleep 1
    s_sub_u32 s42, s42, 1
    s_cmp_lg_u32 s42, 0
    s_cbranch_scc1 pl3
pl3_ok:
    s_branch K_ost
svc12:
    s_call_b64 s[60:61], op_addr
    s_cmp_lg_u32 s32, 3
    s_cbranch_scc1 K_ost
    s_and_b32 s40, s2, 7
    s_lshl_b32 s40, s40, 9
    s_add_u32 s40, s40, 28344320
    v_mov_b32 v3, 0
    v_mov_b32 v4, 1
    s_mov_b64 exec, 1
    buffer_atomic_add v4, v3, s[24:27], s40 offen sc1
    s_mov_b64 exec, -1
    s_branch K_ost
svc13:
    s_cmp_lg_u32 s32, 7
    s_cbranch_scc1 K_ost
    s_and_b32 s40, s2, 7
    s_lshl_b32 s40, s40, 9
    s_add_u32 s40, s40, 28344320
    v_mov_b32 v3, 0
    buffer_load_dword v6, v3, s[24:27], s40 offen sc1
    s_branch K_ost
svc14:
    s_cmp_lg_u32 s32, 3
    s_cbranch_scc1 svctry
    s_and_b32 s40, s2, 7
    s_lshl_b32 s40, s40, 9
    s_add_u32 s40, s40, 28344576
    v_mov_b32 v3, 0
    v_mov_b32 v6, 1
    s_mov_b64 exec, 1
    buffer_atomic_add v6, v3, s[24:27], s40 offen sc0 sc1
    s_mov_b64 exec, -1
    s_and_b32 s40, s2, 3
    s_mul_i32 s40, s40, 983040
    s_lshr_b32 s42, s2, 3
    s_mul_i32 s41, s42, 7680
    s_add_u32 s40, s40, s41
    v_min_u32 v1, 59, v0
    v_lshlrev_b32 v1, 7, v1
    buffer_load_dword v7, v1, s[80:83], s40 offen
    s_add_u32 s40, s40, 245760
    buffer_load_dword v7, v1, s[80:83], s40 offen
    s_add_u32 s40, s40, 245760
    buffer_load_dword v7, v1, s[80:83], s40 offen
    s_add_u32 s40, s40, 245760
    buffer_load_dword v7, v1, s[80:83], s40 offen
    s_add_u32 s40, s40, 245760
    s_branch K_ost
svc15:
    s_cmp_eq_u32 s32, 7
    s_cbranch_scc1 svc15b
    v_mov_b32 v5, 162944
    s_waitcnt vmcnt(4)
    s_mov_b64 exec, 1
    ds_write_b32 v5, v6
    s_mov_b64 exec, -1
    s_branch K_ost
svc15b:
    s_cmp_eq_u32 s23, 1
    s_cbranch_scc1 svc15c
    s_and_b32 s40, s2, 7
    s_lshl_b32 s40, s40, 9
    s_add_u32 s40, s40, 28344320
    s_mov_b32 s42, 0x40000
    v_mov_b32 v3, 0
pl0:
    buffer_load_dword v4, v3, s[24:27], s40 offen sc1
    s_waitcnt vmcnt(0)
    v_readfirstlane_b32 s41, v4
    s_nop 0
    s_lshr_b32 s41, s41, 0
    s_and_b32 s41, s41, 0xff
    s_cmp_ge_u32 s41, 32
    s_cbranch_scc1 pl0_ok
    s_sleep 2
    s_sub_u32 s42, s42, 1
    s_cmp_lg_u32 s42, 0
    s_cbranch_scc1 pl0
pl0_ok:
    buffer_inv sc1
    s_waitcnt vmcnt(0)
    s_branch otouch
svc15c:
    s_waitcnt vmcnt(0)
    s_branch otouch
svctry:
    s_waitcnt vmcnt(0)
    v_readfirstlane_b32 s41, v6
    s_nop 0
    s_cmp_ge_u32 s41, 32
    s_cbranch_scc0 K_ost
    s_mov_b32 s23, 1
    buffer_inv sc1
    s_branch K_ost
otouch:
    s_mul_i32 s40, s28, 8
    s_and_b32 s41, s2, 3
    s_add_u32 s40, s40, s41
    s_mul_i32 s40, s40, 1769472
    s_lshr_b32 s42, s2, 3
    s_mul_i32 s41, s42, 6912
    s_add_u32 s40, s40, s41
    v_min_u32 v1, 53, v0
    v_lshlrev_b32 v1, 7, v1
    buffer_load_dword v7, v1, s[24:27], s40 offen
    s_add_u32 s40, s40, 221184
    buffer_load_dword v7, v1, s[24:27], s40 offen
    s_add_u32 s40, s40, 221184
    buffer_load_dword v7, v1, s[24:27], s40 offen
    s_add_u32 s40, s40, 221184
    buffer_load_dword v7, v1, s[24:27], s40 offen
    s_add_u32 s40, s40, 221184
    buffer_load_dword v7, v1, s[24:27], s40 offen
    s_add_u32 s40, s40, 221184
    buffer_load_dword v7, v1, s[24:27], s40 offen
    s_add_u32 s40, s40, 221184
    buffer_load_dword v7, v1, s[24:27], s40 offen
    s_add_u32 s40, s40, 221184
    buffer_load_dword v7, v1, s[24:27], s40 offen
    s_add_u32 s40, s40, 221184
    s_branch K_ost
svc_st:
    s_call_b64 s[60:61], op_pre
    s_lshr_b32 s40, s50, 4
    s_mul_i32 s40, s40, 7077888
    s_add_u32 s42, s40, s47
    s_lshr_b32 s41, s20, 1
    s_mul_i32 s41, s41, 147456
    s_and_b32 s40, s20, 1
    s_lshl_b32 s40, s40, 10
    s_add_u32 s40, s40, s41
    s_add_u32 s40, s40, s42
    v_add_u32 v1, s40, v35
    s_add_u32 s40, s42, 294912
    v_add_u32 v2, s40, v35
    buffer_store_dwordx4 v[200:203], v1, s[24:27], s69 offen sc1
    buffer_store_dwordx4 v[204:207], v1, s[24:27], s70 offen sc1
    buffer_store_dwordx4 v[208:211], v1, s[24:27], s71 offen sc1
    buffer_store_dwordx4 v[212:215], v1, s[24:27], s72 offen sc1
    buffer_store_dwordx4 v[216:219], v1, s[24:27], s73 offen sc1
    buffer_store_dwordx4 v[232:235], v1, s[24:27], s74 offen sc1
    buffer_store_dwordx4 v[236:239], v1, s[24:27], s75 offen sc1
    buffer_store_dwordx4 v[240:243], v1, s[24:27], s64 offen sc1
    buffer_store_dwordx4 v[244:247], v1, s[24:27], s65 offen sc1
    buffer_store_dwordx4 v[248:251], v2, s[24:27], s69 offen sc1
    buffer_store_dwordx4 v[252:255], v2, s[24:27], s70 offen sc1
    buffer_store_dwordx4 v[12:15], v2, s[24:27], s71 offen sc1
    buffer_store_dwordx4 v[16:19], v2, s[24:27], s72 offen sc1
    buffer_store_dwordx4 v[196:199], v2, s[24:27], s73 offen sc1
    s_branch K_ost
svc8:
    s_lshr_b32 s40, s50, 4
    s_mul_i32 s40, s40, 7077888
    s_add_u32 s42, s40, s47
    s_lshr_b32 s41, s20, 1
    s_mul_i32 s41, s41, 147456
    s_and_b32 s40, s20, 1
    s_lshl_b32 s40, s40, 10
    s_add_u32 s40, s40, s41
    s_add_u32 s40, s40, s42
    v_add_u32 v1, s40, v35
    s_add_u32 s40, s42, 294912
    v_add_u32 v2, s40, v35
    buffer_store_dwordx4 v[200:203], v1, s[24:27], s69 offen sc1
    buffer_store_dwordx4 v[204:207], v1, s[24:27], s70 offen sc1
    buffer_store_dwordx4 v[208:211], v1, s[24:27], s71 offen sc1
    buffer_store_dwordx4 v[212:215], v1, s[24:27], s72 offen sc1
    buffer_store_dwordx4 v[216:219], v1, s[24:27], s73 offen sc1
    s_branch K_ost
svc9:
    s_lshr_b32 s40, s50, 4
    s_mul_i32 s40, s40, 7077888
    s_add_u32 s42, s40, s47
    s_lshr_b32 s41, s20, 1
    s_mul_i32 s41, s41, 147456
    s_and_b32 s40, s20, 1
    s_lshl_b32 s40, s40, 10
    s_add_u32 s40, s40, s41
    s_add_u32 s40, s40, s42
    v_add_u32 v1, s40, v35
    s_add_u32 s40, s42, 294912
    v_add_u32 v2, s40, v35
    buffer_store_dwordx4 v[232:235], v1, s[24:27], s74 offen sc1
    buffer_store_dwordx4 v[236:239], v1, s[24:27], s75 offen sc1
    buffer_store_dwordx4 v[240:243], v1, s[24:27], s64 offen sc1
    buffer_store_dwordx4 v[244:247], v1, s[24:27], s65 offen sc1
    buffer_store_dwordx4 v[248:251], v2, s[24:27], s69 offen sc1
    s_branch K_ost
svc10:
    s_lshr_b32 s40, s50, 4
    s_mul_i32 s40, s40, 7077888
    s_add_u32 s42, s40, s47
    s_lshr_b32 s41, s20, 1
    s_mul_i32 s41, s41, 147456
    s_and_b32 s40, s20, 1
    s_lshl_b32 s40, s40, 10
    s_add_u32 s40, s40, s41
    s_add_u32 s40, s40, s42
    v_add_u32 v1, s40, v35
    s_add_u32 s40, s42, 294912
    v_add_u32 v2, s40, v35
    buffer_store_dwordx4 v[252:255], v2, s[24:27], s70 offen sc1
    buffer_store_dwordx4 v[12:15], v2, s[24:27], s71 offen sc1
    buffer_store_dwordx4 v[16:19], v2, s[24:27], s72 offen sc1
    buffer_store_dwordx4 v[196:199], v2, s[24:27], s73 offen sc1
    s_branch K_ost
R_wX0:
    s_and_b32 s40, s32, 3
    s_cmp_eq_u32 s40, 3
    s_cbranch_scc1 whX0
    s_waitcnt vmcnt(14)
whX0:
    s_waitcnt vmcnt(19)
    s_branch K_wX0
R_fX:
    ds_read_b64_tr_b16 v[152:153], v36 offset:0
    ds_read_b64_tr_b16 v[154:155], v36 offset:1024
    ds_read_b64_tr_b16 v[156:157], v37 offset:0
    ds_read_b64_tr_b16 v[158:159], v37 offset:1024
    ds_read_b64_tr_b16 v[160:161], v38 offset:0
    ds_read_b64_tr_b16 v[162:163], v38 offset:1024
    ds_read_b64_tr_b16 v[164:165], v39 offset:0
    ds_read_b64_tr_b16 v[166:167], v39 offset:1024
    ds_read_b128 v[168:171], v44 offset:0
    ds_read_b128 v[172:175], v44 offset:2048
    ds_read_b128 v[176:179], v44 offset:4096
    ds_read_b128 v[180:183], v44 offset:6144
    ds_read_b128 v[184:187], v44 offset:8192
    ds_read_b128 v[188:191], v44 offset:10240
    s_add_u32 m0, s37, 81920
    s_add_u32 s44, s44, 1
    buffer_load_dwordx4 v9, s[80:83], s34 offen lds
    buffer_load_dwordx4 v9, s[80:83], s35 offen offset:1024 lds
    s_add_u32 m0, s38, 81920
    s_cmp_eq_u32 s44, 12
    buffer_load_dwordx4 v10, s[24:27], s36 offen lds
    buffer_load_dwordx4 v10, s[24:27], s36 offen offset:1024 lds
    buffer_load_dwordx4 v10, s[24:27], s36 offen offset:2048 lds
    s_cselect_b32 s40, 0x2e4000, s45
    s_cselect_b32 s41, 0x534000, s46
    s_add_u32 s34, s34, s40
    s_add_u32 s35, s35, s40
    s_add_u32 s36, s36, s41
    v_mov_b32 v56, 0
    v_mov_b32 v57, 0
    v_mov_b32 v58, 0
    v_mov_b32 v59, 0
    v_mov_b32 v60, 0
    v_mov_b32 v61, 0
    v_mov_b32 v62, 0
    v_mov_b32 v63, 0
    v_mov_b32 v64, 0
    v_mov_b32 v65, 0
    v_mov_b32 v66, 0
    v_mov_b32 v67, 0
    v_mov_b32 v68, 0
    v_mov_b32 v69, 0
    v_mov_b32 v70, 0
    v_mov_b32 v71, 0
    v_mov_b32 v72, 0
    v_mov_b32 v73, 0
    v_mov_b32 v74, 0
    v_mov_b32 v75, 0
    v_mov_b32 v76, 0
    v_mov_b32 v77, 0
    v_mov_b32 v78, 0
    v_mov_b32 v79, 0
    v_mov_b32 v80, 0
    v_mov_b32 v81, 0
    v_mov_b32 v82, 0
    v_mov_b32 v83, 0
    v_mov_b32 v84, 0
    v_mov_b32 v85, 0
    v_mov_b32 v86, 0
    v_mov_b32 v87, 0
    v_mov_b32 v88, 0
    v_mov_b32 v89, 0
    v_mov_b32 v90, 0
    v_mov_b32 v91, 0
    v_mov_b32 v92, 0
    v_mov_b32 v93, 0
    v_mov_b32 v94, 0
    v_mov_b32 v95, 0
    v_mov_b32 v96, 0
    v_mov_b32 v97, 0
    v_mov_b32 v98, 0
    v_mov_b32 v99, 0
    v_mov_b32 v100, 0
    v_mov_b32 v101, 0
    v_mov_b32 v102, 0
    v_mov_b32 v103, 0
    v_mov_b32 v104, 0
    v_mov_b32 v105, 0
    v_mov_b32 v106, 0
    v_mov_b32 v107, 0
    v_mov_b32 v108, 0
    v_mov_b32 v109, 0
    v_mov_b32 v110, 0
    v_mov_b32 v111, 0
    v_mov_b32 v112, 0
    v_mov_b32 v113, 0
    v_mov_b32 v114, 0
    v_mov_b32 v115, 0
    v_mov_b32 v116, 0
    v_mov_b32 v117, 0
    v_mov_b32 v118, 0
    v_mov_b32 v119, 0
    v_mov_b32 v120, 0
    v_mov_b32 v121, 0
    v_mov_b32 v122, 0
    v_mov_b32 v123, 0
    v_mov_b32 v124, 0
    v_mov_b32 v125, 0
    v_mov_b32 v126, 0
    v_mov_b32 v127, 0
    v_mov_b32 v128, 0
    v_mov_b32 v129, 0
    v_mov_b32 v130, 0
    v_mov_b32 v131, 0
    v_mov_b32 v132, 0
    v_mov_b32 v133, 0
    v_mov_b32 v134, 0
    v_mov_b32 v135, 0
    v_mov_b32 v136, 0
    v_mov_b32 v137, 0
    v_mov_b32 v138, 0
    v_mov_b32 v139, 0
    v_mov_b32 v140, 0
    v_mov_b32 v141, 0
    v_mov_b32 v142, 0
    v_mov_b32 v143, 0
    v_mov_b32 v144, 0
    v_mov_b32 v145, 0
    v_mov_b32 v146, 0
    v_mov_b32 v147, 0
    v_mov_b32 v148, 0
    v_mov_b32 v149, 0
    v_mov_b32 v150, 0
    v_mov_b32 v151, 0
    s_waitcnt lgkmcnt(0)
    s_branch K_fX
R_p1:
    s_cmp_lg_u32 s32, 0
    s_cbranch_scc1 K_p1
    s_mov_b32 s42, 0x40000
    v_mov_b32 v3, 0
pl1:
    buffer_load_dword v4, v3, s[24:27], s51 offen sc1
    s_waitcnt vmcnt(0)
    v_readfirstlane_b32 s41, v4
    s_nop 0
    s_lshr_b32 s41, s41, 0
    s_and_b32 s41, s41, 0xff
    s_cmp_ge_u32 s41, 32
    s_cbranch_scc1 pl1_ok
    s_sleep 2
    s_sub_u32 s42, s42, 1
    s_cmp_lg_u32 s42, 0
    s_cbranch_scc1 pl1
pl1_ok:
    buffer_inv sc1
    s_waitcnt vmcnt(0)
    s_branch K_p1
R_wX1:
    s_and_b32 s40, s32, 3
    s_cmp_eq_u32 s40, 3
    s_cbranch_scc1 whX1
    s_waitcnt vmcnt(19)
whX1:
    s_waitcnt vmcnt(24)
    s_branch K_wX1
R_s2:
    s_cmp_lg_u32 s32, 0
    s_cbranch_scc1 K_s2
    v_mov_b32 v3, 0
    v_mov_b32 v4, 1
    s_mov_b64 exec, 1
    buffer_atomic_add v4, v3, s[24:27], s51 offen sc1
    s_mov_b64 exec, -1
    s_branch K_s2
R_wY0:
    s_and_b32 s40, s32, 3
    s_cmp_eq_u32 s40, 3
    s_cbranch_scc1 whY0
    s_waitcnt vmcnt(5)
whY0:
    s_waitcnt vmcnt(19)
    s_branch K_wY0
R_fY:
    ds_read_b64_tr_b16 v[152:153], v36 offset:0
    ds_read_b64_tr_b16 v[154:155], v36 offset:1024
    ds_read_b64_tr_b16 v[156:157], v37 offset:0
    ds_read_b64_tr_b16 v[158:159], v37 offset:1024
    ds_read_b64_tr_b16 v[160:161], v38 offset:0
    ds_read_b64_tr_b16 v[162:163], v38 offset:1024
    ds_read_b64_tr_b16 v[164:165], v39 offset:0
    ds_read_b64_tr_b16 v[166:167], v39 offset:1024
    ds_read_b128 v[168:171], v44 offset:0
    ds_read_b128 v[172:175], v44 offset:2048
    ds_read_b128 v[176:179], v44 offset:4096
    ds_read_b128 v[180:183], v44 offset:6144
    ds_read_b128 v[184:187], v44 offset:8192
    ds_read_b128 v[188:191], v44 offset:10240
    s_add_u32 m0, s37, 81920
    s_add_u32 s44, s44, 1
    buffer_load_dwordx4 v9, s[80:83], s34 offen lds
    buffer_load_dwordx4 v9, s[80:83], s35 offen offset:1024 lds
    s_add_u32 m0, s38, 81920
    s_cmp_eq_u32 s44, 12
    buffer_load_dwordx4 v10, s[24:27], s36 offen lds
    buffer_load_dwordx4 v10, s[24:27], s36 offen offset:1024 lds
    buffer_load_dwordx4 v10, s[24:27], s36 offen offset:2048 lds
    s_cselect_b32 s40, 0x2e4000, s45
    s_cselect_b32 s41, 0x534000, s46
    s_add_u32 s34, s34, s40
    s_add_u32 s35, s35, s40
    s_add_u32 s36, s36, s41
    s_add_u32 m0, s37, 122880
    s_add_u32 s44, s44, 1
    buffer_load_dwordx4 v9, s[80:83], s34 offen lds
    buffer_load_dwordx4 v9, s[80:83], s35 offen offset:1024 lds
    s_add_u32 m0, s38, 122880
    s_cmp_eq_u32 s44, 12
    buffer_load_dwordx4 v10, s[24:27], s36 offen lds
    buffer_load_dwordx4 v10, s[24:27], s36 offen offset:1024 lds
    buffer_load_dwordx4 v10, s[24:27], s36 offen offset:2048 lds
    s_cselect_b32 s40, 0x2e4000, s45
    s_cselect_b32 s41, 0x534000, s46
    s_add_u32 s34, s34, s40
    s_add_u32 s35, s35, s40
    s_add_u32 s36, s36, s41
    v_mov_b32 v56, 0
    v_mov_b32 v57, 0
    v_mov_b32 v58, 0
    v_mov_b32 v59, 0
    v_mov_b32 v60, 0
    v_mov_b32 v61, 0
    v_mov_b32 v62, 0
    v_mov_b32 v63, 0
    v_mov_b32 v64, 0
    v_mov_b32 v65, 0
    v_mov_b32 v66, 0
    v_mov_b32 v67, 0
    v_mov_b32 v68, 0
    v_mov_b32 v69, 0
    v_mov_b32 v70, 0
    v_mov_b32 v71, 0
    v_mov_b32 v72, 0
    v_mov_b32 v73, 0
    v_mov_b32 v74, 0
    v_mov_b32 v75, 0
    v_mov_b32 v76, 0
    v_mov_b32 v77, 0
    v_mov_b32 v78, 0
    v_mov_b32 v79, 0
    v_mov_b32 v80, 0
    v_mov_b32 v81, 0
    v_mov_b32 v82, 0
    v_mov_b32 v83, 0
    v_mov_b32 v84, 0
    v_mov_b32 v85, 0
    v_mov_b32 v86, 0
    v_mov_b32 v87, 0
    v_mov_b32 v88, 0
    v_mov_b32 v89, 0
    v_mov_b32 v90, 0
    v_mov_b32 v91, 0
    v_mov_b32 v92, 0
    v_mov_b32 v93, 0
    v_mov_b32 v94, 0
    v_mov_b32 v95, 0
    v_mov_b32 v96, 0
    v_mov_b32 v97, 0
    v_mov_b32 v98, 0
    v_mov_b32 v99, 0
    v_mov_b32 v100, 0
    v_mov_b32 v101, 0
    v_mov_b32 v102, 0
    v_mov_b32 v103, 0
    v_mov_b32 v104, 0
    v_mov_b32 v105, 0
    v_mov_b32 v106, 0
    v_mov_b32 v107, 0
    v_mov_b32 v108, 0
    v_mov_b32 v109, 0
    v_mov_b32 v110, 0
    v_mov_b32 v111, 0
    v_mov_b32 v112, 0
    v_mov_b32 v113, 0
    v_mov_b32 v114, 0
    v_mov_b32 v115, 0
    v_mov_b32 v116, 0
    v_mov_b32 v117, 0
    v_mov_b32 v118, 0
    v_mov_b32 v119, 0
    v_mov_b32 v120, 0
    v_mov_b32 v121, 0
    v_mov_b32 v122, 0
    v_mov_b32 v123, 0
    v_mov_b32 v124, 0
    v_mov_b32 v125, 0
    v_mov_b32 v126, 0
    v_mov_b32 v127, 0
    v_mov_b32 v128, 0
    v_mov_b32 v129, 0
    v_mov_b32 v130, 0
    v_mov_b32 v131, 0
    v_mov_b32 v132, 0
    v_mov_b32 v133, 0
    v_mov_b32 v134, 0
    v_mov_b32 v135, 0
    v_mov_b32 v136, 0
    v_mov_b32 v137, 0
    v_mov_b32 v138, 0
    v_mov_b32 v139, 0
    v_mov_b32 v140, 0
    v_mov_b32 v141, 0
    v_mov_b32 v142, 0
    v_mov_b32 v143, 0
    v_mov_b32 v144, 0
    v_mov_b32 v145, 0
    v_mov_b32 v146, 0
    v_mov_b32 v147, 0
    v_mov_b32 v148, 0
    v_mov_b32 v149, 0
    v_mov_b32 v150, 0
    v_mov_b32 v151, 0
    s_waitcnt lgkmcnt(0)
    s_branch K_fY
R_wY1:
    s_and_b32 s40, s32, 3
    s_cmp_eq_u32 s40, 3
    s_cbranch_scc1 whY1
    s_waitcnt vmcnt(10)
whY1:
    s_waitcnt vmcnt(24)
    s_branch K_wY1
k1_setup2:
    v_mov_b32 v6, s33
    v_lshrrev_b32 v5, 3, v0
    v_lshl_add_u32 v6, v6, 4, v5
    v_mul_u32_u24 v6, 43, v6
    v_add_u32 v4, 0, v6
    v_lshrrev_b32 v51, 7, v4
    v_lshlrev_b32 v1, 1, v51
    v_and_b32 v1, 28, v1
    v_bfe_u32 v3, s101, v1, 3
    v_xor_b32 v4, v0, v3
    v_lshlrev_b32 v9, 4, v4
    v_add_u32 v4, 0x158, v6
    v_lshrrev_b32 v51, 7, v4
    v_lshlrev_b32 v1, 1, v51
    v_and_b32 v1, 28, v1
    v_bfe_u32 v3, s101, v1, 3
    v_xor_b32 v4, v0, v3
    v_lshlrev_b32 v10, 4, v4
    v_add_u32 v4, 0x2b0, v6
    v_lshrrev_b32 v51, 7, v4
    v_lshlrev_b32 v1, 1, v51
    v_and_b32 v1, 28, v1
    v_bfe_u32 v3, s101, v1, 3
    v_xor_b32 v4, v0, v3
    v_lshlrev_b32 v11, 4, v4
    v_add_u32 v4, 0x408, v6
    v_lshrrev_b32 v51, 7, v4
    v_lshlrev_b32 v1, 1, v51
    v_and_b32 v1, 28, v1
    v_bfe_u32 v3, s101, v1, 3
    v_xor_b32 v4, v0, v3
    v_lshlrev_b32 v232, 4, v4
    v_add_u32 v4, 0x560, v6
    v_lshrrev_b32 v51, 7, v4
    v_lshlrev_b32 v1, 1, v51
    v_and_b32 v1, 28, v1
    v_bfe_u32 v3, s101, v1, 3
    v_xor_b32 v4, v0, v3
    v_lshlrev_b32 v233, 4, v4
    v_add_u32 v4, 0x6b8, v6
    v_lshrrev_b32 v51, 7, v4
    v_lshlrev_b32 v1, 1, v51
    v_and_b32 v1, 28, v1
    v_bfe_u32 v3, s101, v1, 3
    v_xor_b32 v4, v0, v3
    v_lshlrev_b32 v234, 4, v4
    v_and_b32 v51, 15, v0
    v_or_b32 v52, 0, v50
    v_lshlrev_b32 v1, 1, v51
    v_and_b32 v1, 28, v1
    v_bfe_u32 v3, s101, v1, 3
    v_xor_b32 v3, v52, v3
    v_mul_u32_u24 v1, 0x180, v51
    v_lshl_add_u32 v3, v3, 4, v1
    v_add_u32 v24, 0, v3
    v_or_b32 v52, 4, v50
    v_lshlrev_b32 v1, 1, v51
    v_and_b32 v1, 28, v1
    v_bfe_u32 v3, s101, v1, 3
    v_xor_b32 v3, v52, v3
    v_mul_u32_u24 v1, 0x180, v51
    v_lshl_add_u32 v3, v3, 4, v1
    v_add_u32 v25, 0, v3
    s_lshr_b32 s40, s32, 2
    s_lshl_b32 s40, s40, 1
    s_add_u32 s40, s40, 3
    s_cmp_eq_u32 s33, 3
    s_cselect_b32 s20, s40, s33
    v_lshl_or_b32 v51, v50, 2, v48
    v_mov_b32 v5, s20
    v_lshl_or_b32 v52, v5, 2, v49
    v_lshlrev_b32 v1, 1, v51
    v_and_b32 v1, 28, v1
    v_bfe_u32 v3, s101, v1, 3
    v_xor_b32 v3, v52, v3
    v_mul_u32_u24 v1, 0x180, v51
    v_lshl_add_u32 v3, v3, 4, v1
    v_add_u32 v26, 0x12000, v3
    v_or_b32 v52, 16, v49
    v_lshlrev_b32 v1, 1, v51
    v_and_b32 v1, 28, v1
    v_bfe_u32 v3, s101, v1, 3
    v_xor_b32 v3, v52, v3
    v_mul_u32_u24 v1, 0x180, v51
    v_lshl_add_u32 v3, v3, 4, v1
    v_add_u32 v27, 0x12000, v3
    v_add_u32 v30, 0x1e000, v23
    v_add_u32 v29, s44, v30
    s_cmp_eq_u32 s32, 7
    s_cselect_b32 s21, 4, 0
    s_cselect_b32 s41, 9216, 0
    s_lshl_b32 s40, s21, 10
    v_add_u32 v30, s40, v30
    v_subrev_u32 v28, s41, v30
    v_subrev_u32 v5, 16, v0
    v_cmp_gt_u32 vcc, 48, v0
    s_nop 1
    v_cndmask_b32 v5, v5, v0, vcc
    s_mul_i32 s40, s33, 192
    s_add_u32 s40, s40, 159744
    v_lshl_add_u32 v31, v5, 2, s40
    v_min_u32 v5, 35, v0
    v_lshlrev_b32 v5, 4, v5
    v_add_u32 v32, 159744, v5
    v_and_b32 v5, 15, v0
    v_lshlrev_b32 v6, 2, v5
    v_add_u32 v33, 159744, v6
    v_add_u32 v34, 162304, v6
    v_lshlrev_b32 v5, 4, v5
    v_lshrrev_b32 v6, 4, v0
    v_lshl_add_u32 v35, v6, 8, v5
    s_mul_i32 s40, s28, 96
    s_mul_i32 s41, s30, 3
    s_add_u32 s40, s40, s41
    s_mul_i32 s47, s40, 147456
    s_mul_i32 s42, s29, 9
    s_add_u32 s42, s42, s21
    s_add_u32 s40, s42, 0
    s_lshl_b32 s69, s40, 11
    s_add_u32 s40, s42, 1
    s_lshl_b32 s70, s40, 11
    s_add_u32 s40, s42, 2
    s_lshl_b32 s71, s40, 11
    s_add_u32 s40, s42, 3
    s_lshl_b32 s72, s40, 11
    s_add_u32 s40, s42, 4
    s_lshl_b32 s73, s40, 11
    s_cmp_lg_u32 s21, 0
    s_cselect_b32 s40, 9, 0
    s_sub_u32 s42, s42, s40
    s_add_u32 s40, s42, 5
    s_lshl_b32 s74, s40, 11
    s_add_u32 s40, s42, 6
    s_lshl_b32 s75, s40, 11
    s_add_u32 s40, s42, 7
    s_lshl_b32 s64, s40, 11
    s_add_u32 s40, s42, 8
    s_lshl_b32 s65, s40, 11
    s_setpc_b64 s[60:61]
op_pre:
    v_mov_b32 v1, 162944
    ds_read_b32 v2, v1
    s_and_b32 s51, s2, 7
    s_waitcnt lgkmcnt(0)
    v_readfirstlane_b32 s52, v2
    s_nop 0
    s_lshl_b32 s52, s52, 3
    s_add_u32 s52, s52, s51
    s_lshl_b32 s51, s51, 9
    s_add_u32 s51, s51, 28344448
    s_cmp_ge_u32 s52, 240
    s_cbranch_scc1 op_pre_ret
    s_and_b32 s66, s2, 3
    s_lshr_b32 s40, s52, 3
    s_mul_i32 s31, s40, 43
    s_lshr_b32 s31, s31, 8
    s_mul_i32 s41, s31, 6
    s_sub_u32 s30, s40, s41
    s_lshl_b32 s37, s32, 11
    s_mul_i32 s38, s32, 3072
    s_add_u32 s38, s38, 16384
    s_lshr_b32 s48, s32, 2
    s_bfe_u32 s49, s32, 0x10001
    s_and_b32 s68, s32, 1
    s_mul_i32 s44, s66, 12
    s_mul_i32 s34, s44, 81920
    s_mul_i32 s40, s32, 10240
    s_add_u32 s34, s34, s40
    s_lshl_b32 s40, s31, 8
    s_add_u32 s34, s34, s40
    s_add_u32 s35, s34, 4096
    s_mul_i32 s36, s28, 96
    s_add_u32 s36, s36, s44
    s_mul_i32 s36, s36, 147456
    s_add_u32 s67, s36, 7077888
    s_mul_i32 s41, s30, 24576
    s_add_u32 s36, s36, s41
    s_mov_b32 s44, 0
    s_mov_b32 s45, 81920
    s_mov_b32 s46, 147456
    v_lshrrev_b32 v1, 4, v0
    v_lshlrev_b32 v2, 2, v1
    v_and_b32 v3, 15, v0
    v_xor_b32 v2, v2, v3
    v_mov_b32 v3, s68
    v_lshlrev_b32 v3, 1, v3
    v_xor_b32 v2, v2, v3
    v_mul_u32_u24 v1, 0x500, v1
    v_lshl_add_u32 v9, v2, 4, v1
    v_mov_b32 v1, s32
    v_mul_u32_u24 v1, 0xc00, v1
    v_add_u32 v10, v1, v23
    s_add_u32 m0, s37, 0
    s_add_u32 s44, s44, 1
    buffer_load_dwordx4 v9, s[80:83], s34 offen lds
    buffer_load_dwordx4 v9, s[80:83], s35 offen offset:1024 lds
    s_add_u32 m0, s38, 0
    s_cmp_eq_u32 s44, 12
    buffer_load_dwordx4 v10, s[24:27], s36 offen lds
    buffer_load_dwordx4 v10, s[24:27], s36 offen offset:1024 lds
    buffer_load_dwordx4 v10, s[24:27], s36 offen offset:2048 lds
    s_cselect_b32 s40, 0x2e4000, s45
    s_cselect_b32 s41, 0x534000, s46
    s_add_u32 s34, s34, s40
    s_add_u32 s35, s35, s40
    s_add_u32 s36, s36, s41
    s_add_u32 m0, s37, 40960
    s_add_u32 s44, s44, 1
    buffer_load_dwordx4 v9, s[80:83], s34 offen lds
    buffer_load_dwordx4 v9, s[80:83], s35 offen offset:1024 lds
    s_add_u32 m0, s38, 40960
    s_cmp_eq_u32 s44, 12
    buffer_load_dwordx4 v10, s[24:27], s36 offen lds
    buffer_load_dwordx4 v10, s[24:27], s36 offen offset:1024 lds
    buffer_load_dwordx4 v10, s[24:27], s36 offen offset:2048 lds
    s_cselect_b32 s40, 0x2e4000, s45
    s_cselect_b32 s41, 0x534000, s46
    s_add_u32 s34, s34, s40
    s_add_u32 s35, s35, s40
    s_add_u32 s36, s36, s41
op_pre_ret:
    s_setpc_b64 s[60:61]
op_addr:
    v_bfe_u32 v1, v0, 2, 2
    v_lshrrev_b32 v2, 4, v0
    v_and_b32 v3, 1, v2
    v_lshl_or_b32 v3, v1, 1, v3
    v_lshlrev_b32 v3, 1, v3
    v_lshl_or_b32 v2, v2, 3, v1
    v_mov_b32 v6, s32
    v_lshrrev_b32 v6, 2, v6
    v_lshl_add_u32 v2, v6, 5, v2
    v_and_b32 v5, 1, v0
    v_lshlrev_b32 v5, 3, v5
    v_lshl_add_u32 v5, v2, 8, v5
    v_mov_b32 v4, s32
    v_and_b32 v4, 1, v4
    v_lshlrev_b32 v4, 3, v4
    v_bfe_u32 v1, v0, 1, 1
    v_or_b32 v4, v1, v4
    v_xor_b32 v4, v3, v4
    v_xor_b32 v1, 0, v4
    v_lshl_add_u32 v36, v1, 4, v5
    v_add_u32 v40, 0x14000, v36
    v_xor_b32 v1, 2, v4
    v_lshl_add_u32 v37, v1, 4, v5
    v_add_u32 v41, 0x14000, v37
    v_xor_b32 v1, 4, v4
    v_lshl_add_u32 v38, v1, 4, v5
    v_add_u32 v42, 0x14000, v38
    v_xor_b32 v1, 6, v4
    v_lshl_add_u32 v39, v1, 4, v5
    v_add_u32 v43, 0x14000, v39
    v_mov_b32 v1, s32
    v_bfe_u32 v1, v1, 1, 1
    v_mul_u32_u24 v1, 0x3000, v1
    v_lshl_add_u32 v1, v6, 10, v1
    v_add_u32 v1, 0x4000, v1
    v_add_u32 v44, v1, v23
    v_add_u32 v45, 0x14000, v44
    s_setpc_b64 s[60:61]
k1_end:
    s_endpgm
.section .rodata,"a"
.p2align 6
.amdhsa_kernel concat_heads__mha_block_cached__mha_block_cached__near_ridge_kernel
  .amdhsa_next_free_vgpr 256
  .amdhsa_next_free_sgpr 102
  .amdhsa_accum_offset 256
  .amdhsa_group_segment_fixed_size 0
  .amdhsa_kernarg_size 104
  .amdhsa_user_sgpr_count 2
  .amdhsa_user_sgpr_kernarg_segment_ptr 1
  .amdhsa_system_sgpr_workgroup_id_x 1
.end_amdhsa_kernel
```
